```python
import torch

def _softmax(x, axis=-1):
    return torch.softmax(x, dim=axis)
def _gelu(x):
    return torch.nn.functional.gelu(x, approximate="tanh")
def _silu(x):
    return torch.nn.functional.silu(x)
def _sigmoid(x):
    return torch.sigmoid(x)
def _layernorm(x, axis=-1, eps=1e-5):
    m = x.mean(dim=axis, keepdim=True)
    v = x.var(dim=axis, keepdim=True, unbiased=False)
    return (x - m) / torch.sqrt(v + eps)
def _scatter_add(tgt, idx, src, axis=0):
    return tgt.clone().index_add_(axis, idx, src)
def _segment_sum(src, seg, n):
    out = torch.zeros((n,) + src.shape[1:], dtype=src.dtype)
    return out.index_add_(0, seg, src)
def _pad(x, pw):
    flat = tuple(v for pair in reversed(pw) for v in pair)
    return torch.nn.functional.pad(x, flat)

kernel_name = 'gated_mix__ssm_conv_s5__linear_attn_block__prompt'

def setup_inputs():

    _w = (lambda a: (lambda t: t.to(torch.bfloat16) if t.is_floating_point() else t)(torch.as_tensor(a)))
    def _A_setup():
        B, S, D = 1, 2048, 512
        P = D
        Lambda_re = -0.5 * (lambda _x: torch.exp(torch.as_tensor(_x)))((lambda *s: torch.randn(*s, dtype=torch.bfloat16) * 0.2)(P))
        Lambda_im = (lambda *s: torch.randn(*s, dtype=torch.bfloat16) * 0.8)(P) * 1.0
        B_re = (lambda *s: torch.randn(*s, dtype=torch.bfloat16) * 0.4)(P, D) * (D ** -0.5)
        B_im = (lambda *s: torch.randn(*s, dtype=torch.bfloat16) * 0.4)(P, D) * (D ** -0.5)
        C_re = (lambda *s: torch.randn(*s, dtype=torch.bfloat16) * 0.4)(D, P) * (P ** -0.5)
        C_im = (lambda *s: torch.randn(*s, dtype=torch.bfloat16) * 0.4)(D, P) * (P ** -0.5)
        log_dt = (lambda *s: torch.randn(*s, dtype=torch.bfloat16) * 0.2)(P) * 0.3 - 2.0
        Dskip = (lambda *s: torch.randn(*s, dtype=torch.bfloat16) * 0.05)(D)
        return {
            "x": _w((lambda *s: torch.randn(*s, dtype=torch.bfloat16) * 0.05)(B, S, D)),
            "Lambda_re": _w(Lambda_re),
            "Lambda_im": _w(Lambda_im),
            "B_re": _w(B_re),
            "B_im": _w(B_im),
            "C_re": _w(C_re),
            "C_im": _w(C_im),
            "log_dt": _w(log_dt),
            "Dskip": _w(Dskip),
        }
    _A_in = _A_setup()

    def _B_setup():
        B, S, D = 1, 2048, 512
        return {
            "x": _w((lambda *s: torch.randn(*s, dtype=torch.bfloat16) * 0.05)(B, S, D)),
            "wqkv": _w((lambda *s: torch.randn(*s, dtype=torch.bfloat16) * 0.8)(D, 3 * D)),
            "wo": _w((lambda *s: torch.randn(*s, dtype=torch.bfloat16) * 0.05)(D, D)),
        }
    _B_in = _B_setup()

    return {
        "A_x": _A_in["x"],
        "A_Lambda_re": _A_in["Lambda_re"],
        "A_Lambda_im": _A_in["Lambda_im"],
        "A_B_re": _A_in["B_re"],
        "A_B_im": _A_in["B_im"],
        "A_C_re": _A_in["C_re"],
        "A_C_im": _A_in["C_im"],
        "A_log_dt": _A_in["log_dt"],
        "A_Dskip": _A_in["Dskip"],
        "B_x": _B_in["x"],
        "B_wqkv": _B_in["wqkv"],
        "B_wo": _B_in["wo"],
        "gate_w": _w((lambda *s: torch.randn(*s, dtype=torch.bfloat16) * 0.05)(512) * 16.0),
    }

def reference(A_x, A_Lambda_re, A_Lambda_im, A_B_re, A_B_im, A_C_re, A_C_im, A_log_dt, A_Dskip, B_x, B_wqkv, B_wo, gate_w):
    def _A_ref(x, Lambda_re, Lambda_im, B_re, B_im, C_re, C_im, log_dt, Dskip):
        Bsz, L, H = x.shape
        Lam = Lambda_re + 1j * Lambda_im
        Bmat = B_re + 1j * B_im
        Cmat = C_re + 1j * C_im
        dt = torch.exp(log_dt)
        Lam_bar = torch.exp(dt * Lam)
        B_bar = ((Lam_bar - 1.0) / Lam)[:, None] * Bmat
        Bu = torch.einsum("bld,pd->blp", x + 0j, B_bar)
        h = torch.zeros_like(Bu[:, 0, :])
        hs = []
        for t in range(L):
            h = Lam_bar[None, :] * h + Bu[:, t, :]
            hs.append(h)
        hseq = torch.stack(hs, 1)
        y = 2.0 * torch.einsum("blp,dp->bld", hseq, Cmat).real + x * Dskip[None, None, :]
        return y

    def _B_ref(x, wqkv, wo):
        B, S, D = x.shape
        H = 32; Dh = D // H
        qkv = (lambda x, *d: x.permute(*d))((x @ wqkv).reshape(B, S, 3, H, Dh), 2, 0, 3, 1, 4)
        q, k, v = qkv[0], qkv[1], qkv[2]
        phi = lambda t: torch.where(t > 0, t + 1, torch.exp(t)) + 1e-6
        pq, pk = phi(q), phi(k)
        kv = torch.einsum("bhsd,bhse->bhde", pk, v)
        z = torch.einsum("bhsd->bhd", pk)
        num = torch.einsum("bhqd,bhde->bhqe", pq, kv)
        den = torch.einsum("bhqd,bhd->bhq", pq, z)[..., None] + 1e-6
        o = num / den
        return (lambda x, *d: x.permute(*d))(o, 0, 2, 1, 3).reshape(B, S, D) @ wo

    x = A_x
    g = _sigmoid((x * gate_w).sum(-1, keepdims=True))
    a = _A_ref(x, A_Lambda_re, A_Lambda_im, A_B_re, A_B_im, A_C_re, A_C_im, A_log_dt, A_Dskip)
    b = _B_ref(x, B_wqkv, B_wo)
    return g * a + (1 - g) * b
```

```asm
; @launch grid=(256,1,1) block=(256,1,1) lds=163840
.amdgcn_target "amdgcn-amd-amdhsa--gfx950"
.text
.globl gated_mix__ssm_conv_s5__linear_attn_block__prompt_kernel
.p2align 12
.fill 896, 4, 0xbf800000
.p2align 8
.type gated_mix__ssm_conv_s5__linear_attn_block__prompt_kernel,@function
gated_mix__ssm_conv_s5__linear_attn_block__prompt_kernel:
    s_load_dwordx16 s[4:19], s[0:1], 0
    s_load_dwordx16 s[20:35], s[0:1], 64
    s_cmp_ge_u32 s2, 256
    s_cbranch_scc1 L_end
    s_getpc_b64 s[74:75]
L_pc:
    s_and_b32 s72, s2, 0xf8
    v_lshrrev_b32 v4, 5, v0
    v_add_lshl_u32 v4, v4, s72, 7
    v_min_u32 v4, L_end-L_pc, v4
    global_load_dword v80, v4, s[74:75]
    v_lshrrev_b32 v4, 6, v0
    v_and_b32 v0, 63, v0
    v_readfirstlane_b32 s60, v4
    v_mov_b32 v1, 0
    s_and_b32 s72, s2, 7
    s_bfe_u32 s65, s2, 0x30003
    s_lshr_b32 s75, s2, 6
    s_and_b32 s61, s72, 1
    s_lshl3_add_u32 s61, s61, s65
    s_and_b32 s62, s72, 6
    s_lshr_b32 s63, s75, 1
    s_add_u32 s62, s62, s63
    s_lshr_b32 s73, s72, 1
    s_and_b32 s74, s72, 1
    s_lshl2_add_u32 s64, s74, s73
    s_lshl2_add_u32 s64, s64, s75
    s_add_u32 s63, s63, s65
    s_lshl_b32 s63, s63, 2
    s_and_b32 s63, s63, 7
    s_and_b32 s67, s75, 1
    v_lshrrev_b32 v4, 3, v0
    v_and_b32 v5, 7, v0
    v_lshrrev_b32 v6, 4, v0
    v_xor_b32 v7, v5, v6
    v_lshlrev_b32 v7, 4, v7
    v_and_b32 v6, 16, v0
    v_lshlrev_b32 v6, 2, v6
    v_lshlrev_b32 v8, 4, v5
    v_xor_b32 v8, v8, v6
    v_lshrrev_b32 v9, 5, v0
    v_and_b32 v10, 3, v4
    v_lshl_add_u32 v9, v9, 4, v10
    v_lshl_add_u32 v208, v9, 10, v7
    v_xor_b32 v9, 64, v208
    v_add_u32 v209, 3072, v9
    v_add_u32 v210, 6144, v208
    v_add_u32 v211, 9216, v9
    v_lshl_add_u32 v216, v4, 10, v7
    v_xor_b32_e64 v9, 64, v216
    v_add_u32 v217, 7168, v9
    v_add_u32 v218, 14336, v216
    v_add_u32 v219, 21504, v9
    v_lshl_add_u32 v220, v4, 10, v8
    v_lshl_add_u32 v212, v4, 11, v220
    v_xor_b32 v9, 32, v212
    v_add_u32 v213, 23552, v9
    v_add_u32 v214, 47104, v212
    v_add_u32 v215, 70656, v9
    s_lshl_b32 s72, s62, 7
    v_and_b32_e64 v11, 35, v0
    v_bfe_u32 v9, v0, 2, 2
    v_lshl_add_u32 v11, v9, 3, v11
    v_bfe_u32 v9, v0, 4, 1
    v_lshl_add_u32 v11, v9, 2, v11
    v_lshl_add_u32 v11, v11, 1, s72
    v_lshlrev_b32 v13, 4, v0
    s_lshl_b32 s76, s60, 12
    s_add_u32 s77, s76, 16384
    s_and_b32 s80, s60, 1
    s_lshr_b32 s73, s60, 1
    s_lshl2_add_u32 s79, s61, s60
    s_lshl_b32 s68, s79, 15
    s_lshl_b32 s74, s63, 7
    s_add_u32 s68, s68, s74
    s_lshl1_add_u32 s74, s62, s73
    s_lshl_b32 s74, s74, 15
    s_mul_i32 s75, s80, 98304
    s_lshl_b32 s73, s73, 10
    s_add_u32 s75, s75, s73
    s_add_u32 s75, s75, s72
    s_add_u32 s75, s75, 1024
    s_cmp_eq_u32 s67, 0
    s_cselect_b32 s69, s74, s75
    s_mov_b32 s73, 196608
    s_cselect_b32 s70, 0x80, s73
    s_mov_b32 s73, 0x180000
    s_cselect_b32 s42, 0x80000, s73
    s_cselect_b64 exec, -1, 0
    v_and_b32 v9, 32, v0
    v_lshl_add_u32 v212, v9, 7, v216
    v_xor_b32 v9, 64, v212
    v_add_u32 v213, 15360, v9
    v_add_u32 v214, 2048, v212
    v_add_u32 v215, 17408, v9
    v_mov_b64 v[208:209], v[212:213]
    v_mov_b64 v[210:211], v[214:215]
    s_mov_b64 exec, -1
    s_mul_i32 s73, s63, s70
    s_add_u32 s69, s69, s73
    s_mov_b32 s38, 0x200000
    s_mov_b32 s39, 0x20000
    s_mov_b32 s43, 0x20000
    s_mov_b32 m0, s76
    s_mov_b32 s46, 7340032
    s_mov_b32 s47, 0x20000
    s_mov_b32 s50, 0x80000
    s_mov_b32 s51, 0x20000
    s_mov_b32 s54, 0x80000
    s_mov_b32 s55, 0x20000
    s_mov_b32 s58, 0x400000
    s_mov_b32 s59, 0x20000
    s_lshl_b32 s81, s60, 13
    v_add_u32 v221, 7168, v220
    v_add_u32 v222, 14336, v220
    v_add_u32 v223, 21504, v220
    v_and_b32 v4, 31, v0
    v_lshrrev_b32 v5, 5, v0
    v_bfe_u32 v6, v0, 1, 3
    v_xor_b32 v6, v6, v5
    v_lshlrev_b32 v6, 4, v6
    v_lshl_add_u32 v228, v4, 7, v6
    v_xor_b32 v229, 32, v228
    v_xor_b32 v230, 64, v228
    v_xor_b32 v231, 96, v228
    v_add_u32 v224, s76, v228
    v_add_u32 v225, s76, v229
    v_add_u32 v226, s76, v230
    v_add_u32 v227, s76, v231
    v_bfe_u32 v6, v0, 2, 2
    v_bfe_u32 v7, v0, 3, 1
    v_bfe_u32 v8, v0, 4, 1
    v_and_b32 v9, 3, v0
    v_lshlrev_b32 v9, 3, v9
    v_lshl_add_u32 v9, v8, 5, v9
    v_lshl_add_u32 v9, v7, 6, v9
    v_lshl_add_u32 v9, v6, 7, v9
    v_lshl_add_u32 v232, v5, 10, v9
    v_and_b32 v6, 32, v0
    v_xor_b32 v232, v6, v232
    s_cmp_eq_u32 s67, 0
    s_waitcnt lgkmcnt(0)
    s_mov_b64 s[36:37], s[4:5]
    s_cbranch_scc0 L_nopar
    global_load_ushort v176, v11, s[6:7]
    global_load_ushort v177, v11, s[8:9]
    global_load_ushort v178, v11, s[18:19]
    global_load_dword v2, v1, s[34:35] sc1
L_nopar:
    s_cmp_eq_u32 s80, 0
    buffer_load_dwordx4 v208, s[36:39], s68 offen lds
    buffer_load_dwordx4 v209, s[36:39], s68 offen offset:1024 lds
    buffer_load_dwordx4 v210, s[36:39], s68 offen offset:2048 lds
    buffer_load_dwordx4 v211, s[36:39], s68 offen offset:3072 lds
    s_cselect_b64 s[40:41], s[10:11], s[12:13]
    s_cselect_b64 s[48:49], s[14:15], s[16:17]
    s_cmp_eq_u32 s67, 0
    s_cselect_b64 s[40:41], s[40:41], s[24:25]
    s_mov_b32 m0, s77
    s_nop 0
    buffer_load_dwordx4 v212, s[40:43], s69 offen lds
    v_xor_b32 v233, 64, v232
    v_lshl_add_u32 v234, v5, 9, v9
    s_mul_i32 s72, s80, 16448
    v_xor_b32 v234, s72, v234
    v_xor_b32 v235, 64, v234
    v_lshlrev_b32 v14, 2, v0
    s_and_b32 s73, s62, 1
    s_and_b32 s32, s60, 2
    s_add_u32 s32, s32, s60
    s_lshl1_add_u32 s32, s73, s32
    s_lshl_b32 s32, s32, 9
    buffer_load_dwordx4 v213, s[40:43], s69 offen offset:1024 lds
    s_add_u32 s32, s32, s65
    s_lshl_b32 s32, s32, 7
    s_lshr_b32 s33, s60, 1
    s_lshl2_add_u32 s33, s73, s33
    s_lshl_b32 s72, s65, 9
    s_add_u32 s33, s33, s72
    s_lshl_b32 s33, s33, 7
    s_and_b32 s72, s65, 3
    s_lshl_b32 s72, s72, 7
    s_xor_b32 s33, s33, s72
    s_lshl_b32 s72, s72, 9
    buffer_load_dwordx4 v214, s[40:43], s69 offen offset:2048 lds
    s_xor_b32 s32, s32, s72
    s_mul_i32 s72, s80, 69632
    s_lshl_b32 s73, s73, 16
    s_xor_b32 s72, s72, s73
    s_xor_b32 s73, s72, 4096
    v_add_u32 v236, s72, v228
    v_add_u32 v240, s73, v228
    v_add_u32 v237, s72, v229
    v_add_u32 v241, s73, v229
    v_add_u32 v238, s72, v230
    v_add_u32 v242, s73, v230
    buffer_load_dwordx4 v215, s[40:43], s69 offen offset:3072 lds
    v_add_u32 v239, s72, v231
    v_add_u32 v243, s73, v231
    s_mov_b64 s[44:45], s[34:35]
    s_mov_b64 s[52:53], s[26:27]
    s_mov_b64 s[56:57], s[30:31]
    s_add_u32 s68, s68, 128
    s_add_u32 m0, s76, 32768
    s_nop 0
    buffer_load_dwordx4 v208, s[36:39], s68 offen lds
    buffer_load_dwordx4 v209, s[36:39], s68 offen offset:1024 lds
    s_cmp_eq_u32 s67, 0
    s_cbranch_scc0 L_attn
L_ssm:
    v_and_b32 v4, 3, v0
    v_bfe_u32 v5, v0, 2, 2
    v_lshlrev_b32 v6, 7, v5
    v_lshl_add_u32 v6, v4, 10, v6
    s_and_b32 s72, s62, 6
    s_add_u32 s72, s72, s67
    s_lshl_b32 s72, s72, 12
    s_add_u32 s72, s72, s68
    s_lshr_b32 s73, s61, 1
    s_mul_i32 s73, s73, 4096
    s_add_u32 s73, s73, s69
    s_add_u32 s73, s73, 128
    v_add_u32 v171, s73, v6
    v_add_u32 v170, s72, v6
    v_and_b32 v4, 15, v0
    v_lshrrev_b32 v5, 4, v0
    v_lshrrev_b32 v6, 1, v4
    v_xor_b32 v6, v6, v5
    v_lshlrev_b32 v6, 4, v6
    v_lshl_add_u32 v226, v4, 7, v6
    v_xor_b32 v227, 64, v226
    v_add_u32 v224, s76, v226
    v_add_u32 v225, s76, v227
    v_lshlrev_b32 v4, 4, v4
    v_lshl_add_u32 v232, v5, 9, v4
    buffer_load_dwordx4 v210, s[36:39], s68 offen offset:2048 lds
    s_cmp_lt_u32 s60, 2
    s_cselect_b32 s30, 0x400, 0
    s_mov_b32 s31, 0x20000
    s_lshr_b32 s72, s62, 2
    s_lshl1_add_u32 s86, s79, s72
    s_lshl_b32 s86, s86, 8
    s_and_b32 s72, s62, 3
    s_add_u32 s86, s86, s72
    s_lshl2_add_u32 s86, s86, 917504
    s_load_dword s8, s[44:45], s86 glc
    s_lshl_b32 s72, s60, 9
    buffer_load_dwordx4 v211, s[36:39], s68 offen offset:3072 lds
    v_lshlrev_b32 v244, 3, v0
    v_add_u32 v244, 131072, v244
    v_add_u32 v245, s72, v244
    s_lshl4_add_u32 s74, s62, s61
    s_lshl_b32 s74, s74, 10
    s_add_u32 s74, s74, 131072
    s_mul_i32 s101, s79, 98304
    s_lshl_b32 s72, s62, 13
    s_add_u32 s101, s101, s72
    s_add_u32 s101, s101, 1048576
    v_cvt_f32_u32 v10, s60
    s_add_u32 s69, s69, s70
    s_add_u32 m0, s77, 32768
    s_nop 0
    buffer_load_dwordx4 v212, s[40:43], s69 offen lds
    v_mul_f32 v10, 0x42000000, v10
    s_waitcnt vmcnt(13)
    v_readfirstlane_b32 s66, v2
    s_nop 0
    s_mul_i32 s66, s66, 0x9E3779B5
    s_add_u32 s66, s66, 0x7F4A7C15
    v_mov_b32 v12, s66
    v_lshlrev_b32 v176, 16, v176
    v_lshlrev_b32 v177, 16, v177
    v_lshlrev_b32 v178, 16, v178
    v_xor_b32 v177, 0x80000000, v177
    v_mul_f32 v4, 0x3fb8aa3b, v178
    buffer_load_dwordx4 v213, s[40:43], s69 offen offset:1024 lds
    v_exp_f32 v4, v4
    v_mul_f32 v9, v176, v176
    v_cvt_pk_bf16_f32 v4, v4, v4
    v_and_b32 v4, 0xffff0000, v4
    v_mul_f32 v112, v4, v176
    v_mul_f32 v113, v4, v177
    v_mul_f32 v112, 0x3fb8aa3b, v112
    v_mul_f32 v113, 0.15915494, v113
    v_exp_f32 v5, v112
    v_rndne_f32 v7, v113
    v_sub_f32 v6, v113, v7
    buffer_load_dwordx4 v214, s[40:43], s69 offen offset:2048 lds
    v_cos_f32 v7, v6
    v_sin_f32 v8, v6
    v_mul_f32 v184, v5, v7
    v_mul_f32 v185, v5, v8
    v_fmac_f32 v9, v177, v177
    v_rcp_f32 v4, v9
    v_add_f32 v5, -1.0, v184
    v_add_f32 v4, v4, v4
    v_mul_f32 v6, v5, v176
    v_fmac_f32 v6, v185, v177
    v_mul_f32 v7, v185, v176
    buffer_load_dwordx4 v215, s[40:43], s69 offen offset:3072 lds
    s_mov_b64 exec, 0xf0
    buffer_load_dword v169, v170, s[36:39], 0 offen
    buffer_load_dword v169, v171, s[40:43], 0 offen
    s_mov_b64 exec, -1
    s_add_u32 s68, s68, 128
    s_add_u32 m0, s76, 65536
    s_waitcnt vmcnt(10)
    s_barrier
    ds_read_b128 a[0:3], v224 offset:0
    ds_read_b128 a[4:7], v224 offset:2048
    ds_read_b128 v[80:83], v226 offset:16384
    ds_read_b128 v[84:87], v226 offset:18432
    ds_read_b128 v[88:91], v226 offset:20480
    ds_read_b128 v[92:95], v226 offset:22528
    buffer_load_dwordx4 v208, s[36:39], s68 offen lds
    buffer_load_dwordx4 v209, s[36:39], s68 offen offset:1024 lds
    buffer_load_dwordx4 v210, s[36:39], s68 offen offset:2048 lds
    buffer_load_dwordx4 v211, s[36:39], s68 offen offset:3072 lds
    s_add_u32 s69, s69, s70
    s_add_u32 m0, s77, 65536
    s_waitcnt lgkmcnt(2)
    v_mfma_f32_16x16x32_bf16 v[16:19], a[0:3], v[80:83], 0
    ds_read_b128 a[8:11], v225 offset:0
    buffer_load_dwordx4 v212, s[40:43], s69 offen lds
    v_mfma_f32_16x16x32_bf16 v[20:23], a[4:7], v[80:83], 0
    ds_read_b128 v[96:99], v226 offset:24576
    v_mfma_f32_16x16x32_bf16 v[36:39], a[4:7], v[84:87], 0
    ds_read_b128 v[100:103], v226 offset:26624
    buffer_load_dwordx4 v213, s[40:43], s69 offen offset:1024 lds
    v_mfma_f32_16x16x32_bf16 v[32:35], a[0:3], v[84:87], 0
    ds_read_b128 v[104:107], v226 offset:28672
    s_waitcnt lgkmcnt(4)
    v_mfma_f32_16x16x32_bf16 v[24:27], a[0:3], v[88:91], 0
    buffer_load_dwordx4 v214, s[40:43], s69 offen offset:2048 lds
    v_mfma_f32_16x16x32_bf16 v[28:31], a[4:7], v[88:91], 0
    ds_read_b128 v[108:111], v226 offset:30720
    v_mfma_f32_16x16x32_bf16 v[44:47], a[4:7], v[92:95], 0
    buffer_load_dwordx4 v215, s[40:43], s69 offen offset:3072 lds
    v_mfma_f32_16x16x32_bf16 v[40:43], a[0:3], v[92:95], 0
    s_add_u32 s68, s68, 128
    s_add_u32 m0, s76, 98304
    s_mov_b64 exec, 0xf00
    buffer_load_dword v169, v170, s[36:39], 0 offen
    buffer_load_dword v169, v171, s[40:43], 0 offen
    s_mov_b64 exec, -1
    s_waitcnt lgkmcnt(2)
    v_mfma_f32_16x16x32_bf16 v[48:51], a[0:3], v[96:99], 0
    ds_read_b128 a[12:15], v225 offset:2048
    v_mfma_f32_16x16x32_bf16 v[52:55], a[4:7], v[96:99], 0
    ds_read_b128 v[80:83], v227 offset:16384
    v_mfma_f32_16x16x32_bf16 v[68:71], a[4:7], v[100:103], 0
    ds_read_b128 v[84:87], v227 offset:18432
    v_mfma_f32_16x16x32_bf16 v[64:67], a[0:3], v[100:103], 0
    ds_read_b128 v[88:91], v227 offset:20480
    s_waitcnt lgkmcnt(4)
    v_mfma_f32_16x16x32_bf16 v[56:59], a[0:3], v[104:107], 0
    v_mfma_f32_16x16x32_bf16 v[60:63], a[4:7], v[104:107], 0
    ds_read_b128 v[92:95], v227 offset:22528
    v_mfma_f32_16x16x32_bf16 v[76:79], a[4:7], v[108:111], 0
    v_mfma_f32_16x16x32_bf16 v[72:75], a[0:3], v[108:111], 0
    s_waitcnt lgkmcnt(2)
    v_mfma_f32_16x16x32_bf16 v[16:19], a[8:11], v[80:83], v[16:19]
    ds_read_b128 v[96:99], v227 offset:24576
    v_mfma_f32_16x16x32_bf16 v[20:23], a[12:15], v[80:83], v[20:23]
    ds_read_b128 v[100:103], v227 offset:26624
    v_mfma_f32_16x16x32_bf16 v[36:39], a[12:15], v[84:87], v[36:39]
    ds_read_b128 v[104:107], v227 offset:28672
    v_mfma_f32_16x16x32_bf16 v[32:35], a[8:11], v[84:87], v[32:35]
    ds_read_b128 v[108:111], v227 offset:30720
    s_waitcnt lgkmcnt(4)
    v_mfma_f32_16x16x32_bf16 v[24:27], a[8:11], v[88:91], v[24:27]
    v_mfma_f32_16x16x32_bf16 v[28:31], a[12:15], v[88:91], v[28:31]
    v_mfma_f32_16x16x32_bf16 v[44:47], a[12:15], v[92:95], v[44:47]
    v_mfma_f32_16x16x32_bf16 v[40:43], a[8:11], v[92:95], v[40:43]
    v_fma_f32 v7, -v5, v177, v7
    v_mul_f32 v186, v6, v4
    v_mul_f32_e64 v187, v7, v4
    v_pk_mul_f32 v[144:145], v[184:185], v[184:185] op_sel_hi:[0,1]
    v_pk_fma_f32 v[144:145], v[184:185], v[184:185], v[144:145] op_sel:[1,1,0] op_sel_hi:[1,0,1] neg_lo:[0,1,0]
    v_pk_mul_f32 v[6:7], v[144:145], v[144:145] op_sel_hi:[0,1]
    v_pk_fma_f32 v[6:7], v[144:145], v[144:145], v[6:7] op_sel:[1,1,0] op_sel_hi:[1,0,1] neg_lo:[0,1,0]
    v_pk_mul_f32 v[188:189], v[6:7], v[6:7] op_sel_hi:[0,1]
    v_pk_fma_f32 v[188:189], v[6:7], v[6:7], v[188:189] op_sel:[1,1,0] op_sel_hi:[1,0,1] neg_lo:[0,1,0]
    v_pk_mul_f32 v[4:5], v[188:189], v[188:189] op_sel_hi:[0,1]
    v_pk_fma_f32 v[4:5], v[188:189], v[188:189], v[4:5] op_sel:[1,1,0] op_sel_hi:[1,0,1] neg_lo:[0,1,0]
    v_pk_mul_f32 v[190:191], v[4:5], v[4:5] op_sel_hi:[0,1]
    v_pk_fma_f32 v[190:191], v[4:5], v[4:5], v[190:191] op_sel:[1,1,0] op_sel_hi:[1,0,1] neg_lo:[0,1,0]
    v_pk_mul_f32 v[4:5], v[190:191], v[190:191] op_sel_hi:[0,1]
    v_pk_fma_f32 v[4:5], v[190:191], v[190:191], v[4:5] op_sel:[1,1,0] op_sel_hi:[1,0,1] neg_lo:[0,1,0]
    v_pk_mul_f32 v[114:115], v[4:5], v[4:5] op_sel_hi:[0,1]
    v_pk_fma_f32 v[114:115], v[4:5], v[4:5], v[114:115] op_sel:[1,1,0] op_sel_hi:[1,0,1] neg_lo:[0,1,0]
    v_mul_f32 v112, v112, v10
    v_mul_f32 v113, v113, v10
    v_exp_f32 v5, v112
    v_rndne_f32 v7, v113
    v_sub_f32 v6, v113, v7
    v_cos_f32 v7, v6
    v_sin_f32 v8, v6
    v_mul_f32 v200, v5, v7
    v_mul_f32_e64 v201, v5, v8
    v_pk_mul_f32 v[202:203], v[200:201], v[188:189] op_sel_hi:[0,1]
    v_pk_fma_f32 v[202:203], v[200:201], v[188:189], v[202:203] op_sel:[1,1,0] op_sel_hi:[1,0,1] neg_lo:[0,1,0]
    v_pk_mul_f32 v[204:205], v[202:203], v[188:189] op_sel_hi:[0,1]
    v_pk_fma_f32 v[204:205], v[202:203], v[188:189], v[204:205] op_sel:[1,1,0] op_sel_hi:[1,0,1] neg_lo:[0,1,0]
    v_pk_mul_f32 v[206:207], v[204:205], v[188:189] op_sel_hi:[0,1]
    v_pk_fma_f32 v[206:207], v[204:205], v[188:189], v[206:207] op_sel:[1,1,0] op_sel_hi:[1,0,1] neg_lo:[0,1,0]
    v_mul_f32 v112, 0x41800000, v112
    v_mul_f32 v113, 0x41800000, v113
    v_exp_f32 v5, v112
    v_rndne_f32 v7, v113
    v_sub_f32 v6, v113, v7
    v_cos_f32 v7, v6
    v_sin_f32 v8, v6
    v_mul_f32 v10, v5, v7
    v_mul_f32_e64 v11, v5, v8
    v_pk_mul_f32 v[192:193], v[10:11], v[186:187] op_sel_hi:[0,1]
    v_pk_fma_f32 v[192:193], v[10:11], v[186:187], v[192:193] op_sel:[1,1,0] op_sel_hi:[1,0,1] neg_lo:[0,1,0]
    v_pk_mul_f32 v[194:195], v[192:193], v[114:115] op_sel_hi:[0,1]
    v_pk_fma_f32 v[194:195], v[192:193], v[114:115], v[194:195] op_sel:[1,1,0] op_sel_hi:[1,0,1] neg_lo:[0,1,0]
    v_pk_mul_f32 v[196:197], v[194:195], v[114:115] op_sel_hi:[0,1]
    v_pk_fma_f32 v[196:197], v[194:195], v[114:115], v[196:197] op_sel:[1,1,0] op_sel_hi:[1,0,1] neg_lo:[0,1,0]
    v_pk_mul_f32 v[198:199], v[196:197], v[114:115] op_sel_hi:[0,1]
    v_pk_fma_f32 v[198:199], v[196:197], v[114:115], v[198:199] op_sel:[1,1,0] op_sel_hi:[1,0,1] neg_lo:[0,1,0]
    v_mov_b32 v173, v12
    v_mov_b32 v175, v12
    s_lshl2_add_u32 s72, s60, 1
    s_lshl_b32 s84, s72, 10
    s_sub_u32 s84, s74, s84
    s_cmp_le_u32 s72, s61
    s_cselect_b32 s72, s84, 7340032
    s_cselect_b32 s84, s66, 0
    s_lshl2_add_u32 s73, s60, 2
    s_lshl_b32 s85, s73, 10
    s_sub_u32 s85, s74, s85
    s_cmp_le_u32 s73, s61
    s_cselect_b32 s73, s85, 7340032
    s_cselect_b32 s85, s66, 0
    s_lshl2_add_u32 s75, s60, 3
    s_lshl_b32 s82, s75, 10
    s_sub_u32 s82, s74, s82
    s_cmp_le_u32 s75, s61
    s_cselect_b32 s75, s82, 7340032
    s_cselect_b32 s82, s66, 0
    s_lshl2_add_u32 s71, s60, 4
    s_lshl_b32 s83, s71, 10
    s_sub_u32 s83, s74, s83
    s_cmp_le_u32 s71, s61
    s_cselect_b32 s71, s83, 7340032
    s_cselect_b32 s83, s66, 0
    s_lshl3_add_u32 s78, s61, s62
    s_lshl_b32 s78, s78, 12
    s_cmp_lt_u32 s60, 2
    s_cselect_b64 s[22:23], s[48:49], s[26:27]
    s_cselect_b32 s2, 1, 2
    v_lshrrev_b32 v3, s2, v0
    v_lshl_add_u32 v3, v3, 7, s78
    s_cmp_eq_u32 s60, 3
    s_cselect_b32 s2, 0x800, 0
    v_add_u32 v3, s2, v3
    s_and_b32 s78, s79, 31
    s_mul_i32 s78, s78, 384
    s_add_u32 s78, s78, s62
    s_lshl_b32 s78, s78, 7
    v_lshrrev_b32 v15, 2, v0
    v_mul_u32_u24 v15, 3072, v15
    v_add_u32 v15, s78, v15
    s_mov_b64 s[26:27], s[24:25]
    s_lshr_b32 s4, s60, 1
    s_lshl1_add_u32 s4, s64, s4
    s_lshl1_add_u32 s5, s4, s80
    s_lshl_b32 s5, s5, 10
    s_add_u32 s5, s5, 917504
    s_mul_i32 s34, s4, 3
    s_add_u32 s34, s34, s80
    s_and_b32 s35, s65, 3
    s_lshl2_add_u32 s34, s34, s35
    s_lshl_b32 s34, s34, 13
    s_add_u32 s34, s34, 1048576
    s_lshl2_add_u32 s35, s64, s60
    s_lshl_b32 s35, s35, 7
    s_add_u32 s35, s35, s65
    s_lshl_b32 s35, s35, 7
    s_lshr_b32 s24, s76, 1
    s_add_u32 s24, s24, 155648
    s_lshl1_add_u32 s25, s65, s80
    s_lshl_b32 s25, s25, 6
    v_and_b32 v2, 31, v0
    v_lshl_add_u32 v2, v2, 1, s25
    global_load_ushort v2, v2, s[20:21]
    s_waitcnt vmcnt(13)
    s_barrier
    s_waitcnt lgkmcnt(2)
    v_mfma_f32_16x16x32_bf16 v[48:51], a[8:11], v[96:99], v[48:51]
    ds_read_b128 a[16:19], v224 offset:32768
    global_load_dword v15, v15, s[26:27]
    v_mfma_f32_16x16x32_bf16 v[52:55], a[12:15], v[96:99], v[52:55]
    ds_read_b128 a[20:23], v224 offset:34816
    v_mov_b64 v[146:147], v[144:145]
    v_mfma_f32_16x16x32_bf16 v[68:71], a[12:15], v[100:103], v[68:71]
    ds_read_b128 v[80:83], v226 offset:49152
    v_mov_b64 v[148:149], v[144:145]
    v_mfma_f32_16x16x32_bf16 v[64:67], a[8:11], v[100:103], v[64:67]
    ds_read_b128 v[84:87], v226 offset:51200
    s_waitcnt lgkmcnt(4)
    v_mfma_f32_16x16x32_bf16 v[56:59], a[8:11], v[104:107], v[56:59]
    buffer_load_dwordx4 v208, s[36:39], s68 offen lds
    v_mfma_f32_16x16x32_bf16 v[60:63], a[12:15], v[104:107], v[60:63]
    ds_read_b128 v[88:91], v226 offset:53248
    v_mov_b64 v[150:151], v[144:145]
    v_mfma_f32_16x16x32_bf16 v[76:79], a[12:15], v[108:111], v[76:79]
    buffer_load_dwordx4 v209, s[36:39], s68 offen offset:1024 lds
    v_mfma_f32_16x16x32_bf16 v[72:75], a[8:11], v[108:111], v[72:75]
    ds_read_b128 v[92:95], v226 offset:55296
    v_xor_b32 v224, 0x10000, v224
    s_waitcnt lgkmcnt(2)
    v_mfma_f32_16x16x32_bf16 v[16:19], a[16:19], v[80:83], v[16:19]
    ds_read_b128 a[24:27], v225 offset:32768
    v_mov_b64 v[176:177], v[184:185]
    v_mfma_f32_16x16x32_bf16 v[20:23], a[20:23], v[80:83], v[20:23]
    ds_read_b128 v[96:99], v226 offset:57344
    v_mov_b64 v[178:179], v[184:185]
    v_mfma_f32_16x16x32_bf16 v[36:39], a[20:23], v[84:87], v[36:39]
    ds_read_b128 v[100:103], v226 offset:59392
    v_mov_b64 v[180:181], v[184:185]
    v_mfma_f32_16x16x32_bf16 v[32:35], a[16:19], v[84:87], v[32:35]
    ds_read_b128 v[104:107], v226 offset:61440
    s_waitcnt lgkmcnt(4)
    v_mfma_f32_16x16x32_bf16 v[24:27], a[16:19], v[88:91], v[24:27]
    buffer_load_dwordx4 v210, s[36:39], s68 offen offset:2048 lds
    v_mfma_f32_16x16x32_bf16 v[28:31], a[20:23], v[88:91], v[28:31]
    ds_read_b128 v[108:111], v226 offset:63488
    v_mov_b64 v[182:183], v[184:185]
    v_mfma_f32_16x16x32_bf16 v[44:47], a[20:23], v[92:95], v[44:47]
    buffer_load_dwordx4 v211, s[36:39], s68 offen offset:3072 lds
    v_mfma_f32_16x16x32_bf16 v[40:43], a[16:19], v[92:95], v[40:43]
    v_xor_b32 v226, 0x10000, v226
    s_add_u32 s69, s69, s70
    s_add_u32 m0, s77, 98304
    s_waitcnt lgkmcnt(2)
    v_mfma_f32_16x16x32_bf16 v[48:51], a[16:19], v[96:99], v[48:51]
    ds_read_b128 a[28:31], v225 offset:34816
    v_mov_b64 v[246:247], v[186:187]
    v_mfma_f32_16x16x32_bf16 v[52:55], a[20:23], v[96:99], v[52:55]
    ds_read_b128 v[80:83], v227 offset:49152
    v_mov_b64 v[248:249], v[186:187]
    v_mfma_f32_16x16x32_bf16 v[68:71], a[20:23], v[100:103], v[68:71]
    ds_read_b128 v[84:87], v227 offset:51200
    v_mov_b64 v[250:251], v[186:187]
    v_mfma_f32_16x16x32_bf16 v[64:67], a[16:19], v[100:103], v[64:67]
    ds_read_b128 v[88:91], v227 offset:53248
    s_waitcnt lgkmcnt(4)
    v_mfma_f32_16x16x32_bf16 v[56:59], a[16:19], v[104:107], v[56:59]
    buffer_load_dwordx4 v212, s[40:43], s69 offen lds
    v_mfma_f32_16x16x32_bf16 v[60:63], a[20:23], v[104:107], v[60:63]
    ds_read_b128 v[92:95], v227 offset:55296
    v_mov_b64 v[252:253], v[186:187]
    v_mfma_f32_16x16x32_bf16 v[76:79], a[20:23], v[108:111], v[76:79]
    buffer_load_dwordx4 v213, s[40:43], s69 offen offset:1024 lds
    v_mfma_f32_16x16x32_bf16 v[72:75], a[16:19], v[108:111], v[72:75]
    v_xor_b32 v225, 0x10000, v225
    s_waitcnt lgkmcnt(2)
    v_mfma_f32_16x16x32_bf16 v[16:19], a[24:27], v[80:83], v[16:19]
    ds_read_b128 v[96:99], v227 offset:57344
    v_permlane32_swap_b32 v144, v148
    v_mfma_f32_16x16x32_bf16 v[20:23], a[28:31], v[80:83], v[20:23]
    ds_read_b128 v[100:103], v227 offset:59392
    v_permlane32_swap_b32 v146, v150
    v_mfma_f32_16x16x32_bf16 v[36:39], a[28:31], v[84:87], v[36:39]
    ds_read_b128 v[104:107], v227 offset:61440
    v_permlane32_swap_b32 v145, v149
    v_mfma_f32_16x16x32_bf16 v[32:35], a[24:27], v[84:87], v[32:35]
    ds_read_b128 v[108:111], v227 offset:63488
    s_waitcnt lgkmcnt(4)
    v_mfma_f32_16x16x32_bf16 v[24:27], a[24:27], v[88:91], v[24:27]
    buffer_load_dwordx4 v214, s[40:43], s69 offen offset:2048 lds
    v_mfma_f32_16x16x32_bf16 v[28:31], a[28:31], v[88:91], v[28:31]
    v_xor_b32 v227, 0x10000, v227
    v_permlane32_swap_b32 v147, v151
    v_mfma_f32_16x16x32_bf16 v[44:47], a[28:31], v[92:95], v[44:47]
    buffer_load_dwordx4 v215, s[40:43], s69 offen offset:3072 lds
    v_mfma_f32_16x16x32_bf16 v[40:43], a[24:27], v[92:95], v[40:43]
    s_cmp_eq_u32 s63, 4
    s_cselect_b32 s2, -7, 1
    s_mul_i32 s3, s2, s70
    s_lshl_b32 s2, s2, 7
    s_add_u32 s68, s68, s2
    s_add_u32 m0, s76, 0
    s_waitcnt vmcnt(12)
    s_barrier
    s_waitcnt lgkmcnt(2)
    v_mfma_f32_16x16x32_bf16 v[48:51], a[24:27], v[96:99], v[48:51]
    ds_read_b128 a[32:35], v224 offset:0
    v_permlane16_swap_b32 v144, v146
    v_mfma_f32_16x16x32_bf16 v[52:55], a[28:31], v[96:99], v[52:55]
    ds_read_b128 a[36:39], v224 offset:2048
    v_permlane16_swap_b32 v148, v150
    v_mfma_f32_16x16x32_bf16 v[68:71], a[28:31], v[100:103], v[68:71]
    ds_read_b128 v[80:83], v226 offset:16384
    v_permlane16_swap_b32 v145, v147
    v_mfma_f32_16x16x32_bf16 v[64:67], a[24:27], v[100:103], v[64:67]
    ds_read_b128 v[84:87], v226 offset:18432
    s_waitcnt lgkmcnt(4)
    v_mfma_f32_16x16x32_bf16 v[56:59], a[24:27], v[104:107], v[56:59]
    buffer_load_dwordx4 v208, s[36:39], s68 offen lds
    v_mfma_f32_16x16x32_bf16 v[60:63], a[28:31], v[104:107], v[60:63]
    ds_read_b128 v[88:91], v226 offset:20480
    v_permlane16_swap_b32 v149, v151
    v_mfma_f32_16x16x32_bf16 v[76:79], a[28:31], v[108:111], v[76:79]
    buffer_load_dwordx4 v209, s[36:39], s68 offen offset:1024 lds
    v_mfma_f32_16x16x32_bf16 v[72:75], a[24:27], v[108:111], v[72:75]
    ds_read_b128 v[92:95], v226 offset:22528
    s_waitcnt lgkmcnt(2)
    v_mfma_f32_16x16x32_bf16 v[16:19], a[32:35], v[80:83], v[16:19]
    ds_read_b128 a[40:43], v225 offset:0
    v_permlane32_swap_b32 v176, v180
    v_mfma_f32_16x16x32_bf16 v[20:23], a[36:39], v[80:83], v[20:23]
    ds_read_b128 v[96:99], v226 offset:24576
    v_permlane32_swap_b32 v178, v182
    v_mfma_f32_16x16x32_bf16 v[36:39], a[36:39], v[84:87], v[36:39]
    ds_read_b128 v[100:103], v226 offset:26624
    v_permlane32_swap_b32 v177, v181
    v_mfma_f32_16x16x32_bf16 v[32:35], a[32:35], v[84:87], v[32:35]
    ds_read_b128 v[104:107], v226 offset:28672
    s_waitcnt lgkmcnt(4)
    v_mfma_f32_16x16x32_bf16 v[24:27], a[32:35], v[88:91], v[24:27]
    buffer_load_dwordx4 v210, s[36:39], s68 offen offset:2048 lds
    v_mfma_f32_16x16x32_bf16 v[28:31], a[36:39], v[88:91], v[28:31]
    ds_read_b128 v[108:111], v226 offset:30720
    v_permlane32_swap_b32 v179, v183
    v_mfma_f32_16x16x32_bf16 v[44:47], a[36:39], v[92:95], v[44:47]
    buffer_load_dwordx4 v211, s[36:39], s68 offen offset:3072 lds
    v_mfma_f32_16x16x32_bf16 v[40:43], a[32:35], v[92:95], v[40:43]
    s_add_u32 s69, s69, s3
    s_add_u32 m0, s77, 0
    s_waitcnt lgkmcnt(2)
    v_mfma_f32_16x16x32_bf16 v[48:51], a[32:35], v[96:99], v[48:51]
    ds_read_b128 a[44:47], v225 offset:2048
    v_permlane16_swap_b32 v176, v178
    v_mfma_f32_16x16x32_bf16 v[52:55], a[36:39], v[96:99], v[52:55]
    ds_read_b128 v[80:83], v227 offset:16384
    v_permlane16_swap_b32 v180, v182
    v_mfma_f32_16x16x32_bf16 v[68:71], a[36:39], v[100:103], v[68:71]
    ds_read_b128 v[84:87], v227 offset:18432
    v_permlane16_swap_b32 v177, v179
    v_mfma_f32_16x16x32_bf16 v[64:67], a[32:35], v[100:103], v[64:67]
    ds_read_b128 v[88:91], v227 offset:20480
    s_waitcnt lgkmcnt(4)
    v_mfma_f32_16x16x32_bf16 v[56:59], a[32:35], v[104:107], v[56:59]
    buffer_load_dwordx4 v212, s[40:43], s69 offen lds
    v_mfma_f32_16x16x32_bf16 v[60:63], a[36:39], v[104:107], v[60:63]
    ds_read_b128 v[92:95], v227 offset:22528
    v_permlane16_swap_b32 v181, v183
    v_mfma_f32_16x16x32_bf16 v[76:79], a[36:39], v[108:111], v[76:79]
    buffer_load_dwordx4 v213, s[40:43], s69 offen offset:1024 lds
    v_mfma_f32_16x16x32_bf16 v[72:75], a[32:35], v[108:111], v[72:75]
    s_waitcnt lgkmcnt(2)
    v_mfma_f32_16x16x32_bf16 v[16:19], a[40:43], v[80:83], v[16:19]
    ds_read_b128 v[96:99], v227 offset:24576
    v_permlane32_swap_b32 v246, v250
    v_mfma_f32_16x16x32_bf16 v[20:23], a[44:47], v[80:83], v[20:23]
    ds_read_b128 v[100:103], v227 offset:26624
    v_permlane32_swap_b32 v248, v252
    v_mfma_f32_16x16x32_bf16 v[36:39], a[44:47], v[84:87], v[36:39]
    ds_read_b128 v[104:107], v227 offset:28672
    v_permlane32_swap_b32 v247, v251
    v_mfma_f32_16x16x32_bf16 v[32:35], a[40:43], v[84:87], v[32:35]
    ds_read_b128 v[108:111], v227 offset:30720
    s_waitcnt lgkmcnt(4)
    v_mfma_f32_16x16x32_bf16 v[24:27], a[40:43], v[88:91], v[24:27]
    buffer_load_dwordx4 v214, s[40:43], s69 offen offset:2048 lds
    v_mfma_f32_16x16x32_bf16 v[28:31], a[44:47], v[88:91], v[28:31]
    v_permlane32_swap_b32 v249, v253
    v_mfma_f32_16x16x32_bf16 v[44:47], a[44:47], v[92:95], v[44:47]
    buffer_load_dwordx4 v215, s[40:43], s69 offen offset:3072 lds
    v_mfma_f32_16x16x32_bf16 v[40:43], a[40:43], v[92:95], v[40:43]
    s_add_u32 s68, s68, 128
    s_add_u32 m0, s76, 32768
    s_waitcnt vmcnt(8)
    s_barrier
    s_waitcnt lgkmcnt(2)
    v_mfma_f32_16x16x32_bf16 v[48:51], a[40:43], v[96:99], v[48:51]
    ds_read_b128 a[48:51], v224 offset:32768
    v_permlane16_swap_b32 v246, v248
    v_mfma_f32_16x16x32_bf16 v[52:55], a[44:47], v[96:99], v[52:55]
    ds_read_b128 a[52:55], v224 offset:34816
    v_permlane16_swap_b32 v250, v252
    v_mfma_f32_16x16x32_bf16 v[68:71], a[44:47], v[100:103], v[68:71]
    ds_read_b128 v[80:83], v226 offset:49152
    v_permlane16_swap_b32 v247, v249
    v_mfma_f32_16x16x32_bf16 v[64:67], a[40:43], v[100:103], v[64:67]
    ds_read_b128 v[84:87], v226 offset:51200
    s_waitcnt lgkmcnt(4)
    v_mfma_f32_16x16x32_bf16 v[56:59], a[40:43], v[104:107], v[56:59]
    buffer_load_dwordx4 v208, s[36:39], s68 offen lds
    v_mfma_f32_16x16x32_bf16 v[60:63], a[44:47], v[104:107], v[60:63]
    ds_read_b128 v[88:91], v226 offset:53248
    v_permlane16_swap_b32 v251, v253
    v_mfma_f32_16x16x32_bf16 v[76:79], a[44:47], v[108:111], v[76:79]
    buffer_load_dwordx4 v209, s[36:39], s68 offen offset:1024 lds
    v_mfma_f32_16x16x32_bf16 v[72:75], a[40:43], v[108:111], v[72:75]
    ds_read_b128 v[92:95], v226 offset:55296
    v_xor_b32 v224, 0x10000, v224
    s_waitcnt lgkmcnt(2)
    v_mfma_f32_16x16x32_bf16 v[16:19], a[48:51], v[80:83], v[16:19]
    ds_read_b128 a[56:59], v225 offset:32768
    v_mfma_f32_16x16x32_bf16 v[20:23], a[52:55], v[80:83], v[20:23]
    ds_read_b128 v[96:99], v226 offset:57344
    v_mfma_f32_16x16x32_bf16 v[36:39], a[52:55], v[84:87], v[36:39]
    ds_read_b128 v[100:103], v226 offset:59392
    v_mfma_f32_16x16x32_bf16 v[32:35], a[48:51], v[84:87], v[32:35]
    ds_read_b128 v[104:107], v226 offset:61440
    s_waitcnt lgkmcnt(4)
    v_mfma_f32_16x16x32_bf16 v[24:27], a[48:51], v[88:91], v[24:27]
    buffer_load_dwordx4 v210, s[36:39], s68 offen offset:2048 lds
    v_mfma_f32_16x16x32_bf16 v[28:31], a[52:55], v[88:91], v[28:31]
    ds_read_b128 v[108:111], v226 offset:63488
    v_mfma_f32_16x16x32_bf16 v[44:47], a[52:55], v[92:95], v[44:47]
    buffer_load_dwordx4 v211, s[36:39], s68 offen offset:3072 lds
    v_mfma_f32_16x16x32_bf16 v[40:43], a[48:51], v[92:95], v[40:43]
    v_xor_b32 v226, 0x10000, v226
    s_add_u32 s69, s69, s70
    s_add_u32 m0, s77, 32768
    s_waitcnt lgkmcnt(2)
    v_mfma_f32_16x16x32_bf16 v[48:51], a[48:51], v[96:99], v[48:51]
    ds_read_b128 a[60:63], v225 offset:34816
    v_mfma_f32_16x16x32_bf16 v[52:55], a[52:55], v[96:99], v[52:55]
    ds_read_b128 v[80:83], v227 offset:49152
    v_mfma_f32_16x16x32_bf16 v[68:71], a[52:55], v[100:103], v[68:71]
    ds_read_b128 v[84:87], v227 offset:51200
    v_mfma_f32_16x16x32_bf16 v[64:67], a[48:51], v[100:103], v[64:67]
    ds_read_b128 v[88:91], v227 offset:53248
    s_waitcnt lgkmcnt(4)
    v_mfma_f32_16x16x32_bf16 v[56:59], a[48:51], v[104:107], v[56:59]
    buffer_load_dwordx4 v212, s[40:43], s69 offen lds
    v_mfma_f32_16x16x32_bf16 v[60:63], a[52:55], v[104:107], v[60:63]
    ds_read_b128 v[92:95], v227 offset:55296
    v_mfma_f32_16x16x32_bf16 v[76:79], a[52:55], v[108:111], v[76:79]
    buffer_load_dwordx4 v213, s[40:43], s69 offen offset:1024 lds
    v_mfma_f32_16x16x32_bf16 v[72:75], a[48:51], v[108:111], v[72:75]
    v_xor_b32 v225, 0x10000, v225
    s_waitcnt lgkmcnt(2)
    v_mfma_f32_16x16x32_bf16 v[16:19], a[56:59], v[80:83], v[16:19]
    ds_read_b128 v[96:99], v227 offset:57344
    v_mfma_f32_16x16x32_bf16 v[20:23], a[60:63], v[80:83], v[20:23]
    ds_read_b128 v[100:103], v227 offset:59392
    v_mfma_f32_16x16x32_bf16 v[36:39], a[60:63], v[84:87], v[36:39]
    ds_read_b128 v[104:107], v227 offset:61440
    v_mfma_f32_16x16x32_bf16 v[32:35], a[56:59], v[84:87], v[32:35]
    ds_read_b128 v[108:111], v227 offset:63488
    s_waitcnt lgkmcnt(4)
    v_mfma_f32_16x16x32_bf16 v[24:27], a[56:59], v[88:91], v[24:27]
    buffer_load_dwordx4 v214, s[40:43], s69 offen offset:2048 lds
    v_mfma_f32_16x16x32_bf16 v[28:31], a[60:63], v[88:91], v[28:31]
    v_xor_b32 v227, 0x10000, v227
    v_mfma_f32_16x16x32_bf16 v[44:47], a[60:63], v[92:95], v[44:47]
    buffer_load_dwordx4 v215, s[40:43], s69 offen offset:3072 lds
    v_mfma_f32_16x16x32_bf16 v[40:43], a[56:59], v[92:95], v[40:43]
    s_add_u32 s68, s68, 128
    s_add_u32 m0, s76, 65536
    s_waitcnt vmcnt(8)
    s_barrier
    s_waitcnt lgkmcnt(2)
    v_mfma_f32_16x16x32_bf16 v[48:51], a[56:59], v[96:99], v[48:51]
    ds_read_b128 a[64:67], v224 offset:0
    v_mfma_f32_16x16x32_bf16 v[52:55], a[60:63], v[96:99], v[52:55]
    ds_read_b128 a[68:71], v224 offset:2048
    v_mfma_f32_16x16x32_bf16 v[68:71], a[60:63], v[100:103], v[68:71]
    ds_read_b128 v[80:83], v226 offset:16384
    v_mfma_f32_16x16x32_bf16 v[64:67], a[56:59], v[100:103], v[64:67]
    ds_read_b128 v[84:87], v226 offset:18432
    s_waitcnt lgkmcnt(4)
    v_mfma_f32_16x16x32_bf16 v[56:59], a[56:59], v[104:107], v[56:59]
    buffer_load_dwordx4 v208, s[36:39], s68 offen lds
    v_mfma_f32_16x16x32_bf16 v[60:63], a[60:63], v[104:107], v[60:63]
    ds_read_b128 v[88:91], v226 offset:20480
    v_mfma_f32_16x16x32_bf16 v[76:79], a[60:63], v[108:111], v[76:79]
    buffer_load_dwordx4 v209, s[36:39], s68 offen offset:1024 lds
    v_mfma_f32_16x16x32_bf16 v[72:75], a[56:59], v[108:111], v[72:75]
    ds_read_b128 v[92:95], v226 offset:22528
    s_waitcnt lgkmcnt(2)
    v_mfma_f32_16x16x32_bf16 v[16:19], a[64:67], v[80:83], v[16:19]
    ds_read_b128 a[72:75], v225 offset:0
    v_mfma_f32_16x16x32_bf16 v[20:23], a[68:71], v[80:83], v[20:23]
    ds_read_b128 v[96:99], v226 offset:24576
    v_mfma_f32_16x16x32_bf16 v[36:39], a[68:71], v[84:87], v[36:39]
    ds_read_b128 v[100:103], v226 offset:26624
    v_mfma_f32_16x16x32_bf16 v[32:35], a[64:67], v[84:87], v[32:35]
    ds_read_b128 v[104:107], v226 offset:28672
    s_waitcnt lgkmcnt(4)
    v_mfma_f32_16x16x32_bf16 v[24:27], a[64:67], v[88:91], v[24:27]
    buffer_load_dwordx4 v210, s[36:39], s68 offen offset:2048 lds
    v_mfma_f32_16x16x32_bf16 v[28:31], a[68:71], v[88:91], v[28:31]
    ds_read_b128 v[108:111], v226 offset:30720
    v_mfma_f32_16x16x32_bf16 v[44:47], a[68:71], v[92:95], v[44:47]
    buffer_load_dwordx4 v211, s[36:39], s68 offen offset:3072 lds
    v_mfma_f32_16x16x32_bf16 v[40:43], a[64:67], v[92:95], v[40:43]
    s_add_u32 s69, s69, s70
    s_add_u32 m0, s77, 65536
    s_waitcnt lgkmcnt(2)
    v_mfma_f32_16x16x32_bf16 v[48:51], a[64:67], v[96:99], v[48:51]
    ds_read_b128 a[76:79], v225 offset:2048
    v_mfma_f32_16x16x32_bf16 v[52:55], a[68:71], v[96:99], v[52:55]
    ds_read_b128 v[80:83], v227 offset:16384
    v_mfma_f32_16x16x32_bf16 v[68:71], a[68:71], v[100:103], v[68:71]
    ds_read_b128 v[84:87], v227 offset:18432
    v_mfma_f32_16x16x32_bf16 v[64:67], a[64:67], v[100:103], v[64:67]
    ds_read_b128 v[88:91], v227 offset:20480
    s_waitcnt lgkmcnt(4)
    v_mfma_f32_16x16x32_bf16 v[56:59], a[64:67], v[104:107], v[56:59]
    buffer_load_dwordx4 v212, s[40:43], s69 offen lds
    v_mfma_f32_16x16x32_bf16 v[60:63], a[68:71], v[104:107], v[60:63]
    ds_read_b128 v[92:95], v227 offset:22528
    v_mfma_f32_16x16x32_bf16 v[76:79], a[68:71], v[108:111], v[76:79]
    buffer_load_dwordx4 v213, s[40:43], s69 offen offset:1024 lds
    v_mfma_f32_16x16x32_bf16 v[72:75], a[64:67], v[108:111], v[72:75]
    s_waitcnt lgkmcnt(2)
    v_mfma_f32_16x16x32_bf16 v[16:19], a[72:75], v[80:83], v[16:19]
    ds_read_b128 v[96:99], v227 offset:24576
    v_mfma_f32_16x16x32_bf16 v[20:23], a[76:79], v[80:83], v[20:23]
    ds_read_b128 v[100:103], v227 offset:26624
    v_mfma_f32_16x16x32_bf16 v[36:39], a[76:79], v[84:87], v[36:39]
    ds_read_b128 v[104:107], v227 offset:28672
    v_mfma_f32_16x16x32_bf16 v[32:35], a[72:75], v[84:87], v[32:35]
    ds_read_b128 v[108:111], v227 offset:30720
    s_waitcnt lgkmcnt(4)
    v_mfma_f32_16x16x32_bf16 v[24:27], a[72:75], v[88:91], v[24:27]
    buffer_load_dwordx4 v214, s[40:43], s69 offen offset:2048 lds
    v_mfma_f32_16x16x32_bf16 v[28:31], a[76:79], v[88:91], v[28:31]
    v_mfma_f32_16x16x32_bf16 v[44:47], a[76:79], v[92:95], v[44:47]
    buffer_load_dwordx4 v215, s[40:43], s69 offen offset:3072 lds
    v_mfma_f32_16x16x32_bf16 v[40:43], a[72:75], v[92:95], v[40:43]
    s_add_u32 s68, s68, 128
    s_add_u32 m0, s76, 98304
    s_waitcnt vmcnt(8)
    s_barrier
    s_waitcnt lgkmcnt(2)
    v_mfma_f32_16x16x32_bf16 v[48:51], a[72:75], v[96:99], v[48:51]
    ds_read_b128 a[80:83], v224 offset:32768
    v_mfma_f32_16x16x32_bf16 v[52:55], a[76:79], v[96:99], v[52:55]
    ds_read_b128 a[84:87], v224 offset:34816
    v_mfma_f32_16x16x32_bf16 v[68:71], a[76:79], v[100:103], v[68:71]
    ds_read_b128 v[80:83], v226 offset:49152
    v_mfma_f32_16x16x32_bf16 v[64:67], a[72:75], v[100:103], v[64:67]
    ds_read_b128 v[84:87], v226 offset:51200
    s_waitcnt lgkmcnt(4)
    v_mfma_f32_16x16x32_bf16 v[56:59], a[72:75], v[104:107], v[56:59]
    buffer_load_dwordx4 v208, s[36:39], s68 offen lds
    v_mfma_f32_16x16x32_bf16 v[60:63], a[76:79], v[104:107], v[60:63]
    ds_read_b128 v[88:91], v226 offset:53248
    v_mfma_f32_16x16x32_bf16 v[76:79], a[76:79], v[108:111], v[76:79]
    buffer_load_dwordx4 v209, s[36:39], s68 offen offset:1024 lds
    v_mfma_f32_16x16x32_bf16 v[72:75], a[72:75], v[108:111], v[72:75]
    ds_read_b128 v[92:95], v226 offset:55296
    v_xor_b32 v224, 0x10000, v224
    s_waitcnt lgkmcnt(2)
    v_mfma_f32_16x16x32_bf16 v[16:19], a[80:83], v[80:83], v[16:19]
    ds_read_b128 a[88:91], v225 offset:32768
    v_mfma_f32_16x16x32_bf16 v[20:23], a[84:87], v[80:83], v[20:23]
    ds_read_b128 v[96:99], v226 offset:57344
    v_mfma_f32_16x16x32_bf16 v[36:39], a[84:87], v[84:87], v[36:39]
    ds_read_b128 v[100:103], v226 offset:59392
    v_mfma_f32_16x16x32_bf16 v[32:35], a[80:83], v[84:87], v[32:35]
    ds_read_b128 v[104:107], v226 offset:61440
    s_waitcnt lgkmcnt(4)
    v_mfma_f32_16x16x32_bf16 v[24:27], a[80:83], v[88:91], v[24:27]
    buffer_load_dwordx4 v210, s[36:39], s68 offen offset:2048 lds
    v_mfma_f32_16x16x32_bf16 v[28:31], a[84:87], v[88:91], v[28:31]
    ds_read_b128 v[108:111], v226 offset:63488
    v_mfma_f32_16x16x32_bf16 v[44:47], a[84:87], v[92:95], v[44:47]
    buffer_load_dwordx4 v211, s[36:39], s68 offen offset:3072 lds
    v_mfma_f32_16x16x32_bf16 v[40:43], a[80:83], v[92:95], v[40:43]
    v_xor_b32 v226, 0x10000, v226
    s_add_u32 s69, s69, s70
    s_add_u32 m0, s77, 98304
    s_waitcnt lgkmcnt(2)
    v_mfma_f32_16x16x32_bf16 v[48:51], a[80:83], v[96:99], v[48:51]
    ds_read_b128 a[92:95], v225 offset:34816
    v_mfma_f32_16x16x32_bf16 v[52:55], a[84:87], v[96:99], v[52:55]
    ds_read_b128 v[80:83], v227 offset:49152
    v_mfma_f32_16x16x32_bf16 v[68:71], a[84:87], v[100:103], v[68:71]
    ds_read_b128 v[84:87], v227 offset:51200
    v_mfma_f32_16x16x32_bf16 v[64:67], a[80:83], v[100:103], v[64:67]
    ds_read_b128 v[88:91], v227 offset:53248
    s_waitcnt lgkmcnt(4)
    v_mfma_f32_16x16x32_bf16 v[56:59], a[80:83], v[104:107], v[56:59]
    buffer_load_dwordx4 v212, s[40:43], s69 offen lds
    v_mfma_f32_16x16x32_bf16 v[60:63], a[84:87], v[104:107], v[60:63]
    ds_read_b128 v[92:95], v227 offset:55296
    v_mfma_f32_16x16x32_bf16 v[76:79], a[84:87], v[108:111], v[76:79]
    buffer_load_dwordx4 v213, s[40:43], s69 offen offset:1024 lds
    v_mfma_f32_16x16x32_bf16 v[72:75], a[80:83], v[108:111], v[72:75]
    v_xor_b32 v225, 0x10000, v225
    s_waitcnt lgkmcnt(2)
    v_mfma_f32_16x16x32_bf16 v[16:19], a[88:91], v[80:83], v[16:19]
    ds_read_b128 v[96:99], v227 offset:57344
    v_mfma_f32_16x16x32_bf16 v[20:23], a[92:95], v[80:83], v[20:23]
    ds_read_b128 v[100:103], v227 offset:59392
    v_mfma_f32_16x16x32_bf16 v[36:39], a[92:95], v[84:87], v[36:39]
    ds_read_b128 v[104:107], v227 offset:61440
    v_mfma_f32_16x16x32_bf16 v[32:35], a[88:91], v[84:87], v[32:35]
    ds_read_b128 v[108:111], v227 offset:63488
    s_waitcnt lgkmcnt(4)
    v_mfma_f32_16x16x32_bf16 v[24:27], a[88:91], v[88:91], v[24:27]
    buffer_load_dwordx4 v214, s[40:43], s69 offen offset:2048 lds
    v_mfma_f32_16x16x32_bf16 v[28:31], a[92:95], v[88:91], v[28:31]
    v_xor_b32 v227, 0x10000, v227
    v_mfma_f32_16x16x32_bf16 v[44:47], a[92:95], v[92:95], v[44:47]
    buffer_load_dwordx4 v215, s[40:43], s69 offen offset:3072 lds
    v_mfma_f32_16x16x32_bf16 v[40:43], a[88:91], v[92:95], v[40:43]
    s_xor_b32 s2, s32, 0
    s_add_u32 m0, s81, 0
    s_waitcnt vmcnt(8)
    s_barrier
    s_waitcnt lgkmcnt(2)
    v_mfma_f32_16x16x32_bf16 v[48:51], a[88:91], v[96:99], v[48:51]
    ds_read_b128 a[96:99], v224 offset:0
    v_mfma_f32_16x16x32_bf16 v[52:55], a[92:95], v[96:99], v[52:55]
    ds_read_b128 a[100:103], v224 offset:2048
    v_mfma_f32_16x16x32_bf16 v[68:71], a[92:95], v[100:103], v[68:71]
    ds_read_b128 v[80:83], v226 offset:16384
    v_mfma_f32_16x16x32_bf16 v[64:67], a[88:91], v[100:103], v[64:67]
    ds_read_b128 v[84:87], v226 offset:18432
    s_waitcnt lgkmcnt(4)
    v_mfma_f32_16x16x32_bf16 v[56:59], a[88:91], v[104:107], v[56:59]
    buffer_load_dwordx4 v220, s[52:55], s2 offen lds
    v_mfma_f32_16x16x32_bf16 v[60:63], a[92:95], v[104:107], v[60:63]
    ds_read_b128 v[88:91], v226 offset:20480
    v_mfma_f32_16x16x32_bf16 v[76:79], a[92:95], v[108:111], v[76:79]
    buffer_load_dwordx4 v221, s[52:55], s2 offen offset:1024 lds
    v_mfma_f32_16x16x32_bf16 v[72:75], a[88:91], v[108:111], v[72:75]
    ds_read_b128 v[92:95], v226 offset:22528
    s_waitcnt lgkmcnt(2)
    v_mfma_f32_16x16x32_bf16 v[16:19], a[96:99], v[80:83], v[16:19]
    ds_read_b128 a[104:107], v225 offset:0
    v_mfma_f32_16x16x32_bf16 v[20:23], a[100:103], v[80:83], v[20:23]
    ds_read_b128 v[96:99], v226 offset:24576
    v_mfma_f32_16x16x32_bf16 v[36:39], a[100:103], v[84:87], v[36:39]
    ds_read_b128 v[100:103], v226 offset:26624
    v_mfma_f32_16x16x32_bf16 v[32:35], a[96:99], v[84:87], v[32:35]
    ds_read_b128 v[104:107], v226 offset:28672
    s_waitcnt lgkmcnt(4)
    v_mfma_f32_16x16x32_bf16 v[24:27], a[96:99], v[88:91], v[24:27]
    buffer_load_dwordx4 v222, s[52:55], s2 offen offset:2048 lds
    v_mfma_f32_16x16x32_bf16 v[28:31], a[100:103], v[88:91], v[28:31]
    ds_read_b128 v[108:111], v226 offset:30720
    v_mfma_f32_16x16x32_bf16 v[44:47], a[100:103], v[92:95], v[44:47]
    buffer_load_dwordx4 v223, s[52:55], s2 offen offset:3072 lds
    v_mfma_f32_16x16x32_bf16 v[40:43], a[96:99], v[92:95], v[40:43]
    s_add_u32 s2, s2, 32768
    s_add_u32 m0, s81, 4096
    s_waitcnt lgkmcnt(2)
    v_mfma_f32_16x16x32_bf16 v[48:51], a[96:99], v[96:99], v[48:51]
    ds_read_b128 a[108:111], v225 offset:2048
    v_mfma_f32_16x16x32_bf16 v[52:55], a[100:103], v[96:99], v[52:55]
    ds_read_b128 v[80:83], v227 offset:16384
    v_mfma_f32_16x16x32_bf16 v[68:71], a[100:103], v[100:103], v[68:71]
    ds_read_b128 v[84:87], v227 offset:18432
    v_mfma_f32_16x16x32_bf16 v[64:67], a[96:99], v[100:103], v[64:67]
    ds_read_b128 v[88:91], v227 offset:20480
    s_waitcnt lgkmcnt(4)
    v_mfma_f32_16x16x32_bf16 v[56:59], a[96:99], v[104:107], v[56:59]
    buffer_load_dwordx4 v220, s[52:55], s2 offen lds
    v_mfma_f32_16x16x32_bf16 v[60:63], a[100:103], v[104:107], v[60:63]
    ds_read_b128 v[92:95], v227 offset:22528
    v_mfma_f32_16x16x32_bf16 v[76:79], a[100:103], v[108:111], v[76:79]
    buffer_load_dwordx4 v221, s[52:55], s2 offen offset:1024 lds
    v_mfma_f32_16x16x32_bf16 v[72:75], a[96:99], v[108:111], v[72:75]
    s_waitcnt lgkmcnt(2)
    v_mfma_f32_16x16x32_bf16 v[16:19], a[104:107], v[80:83], v[16:19]
    ds_read_b128 v[96:99], v227 offset:24576
    v_mfma_f32_16x16x32_bf16 v[20:23], a[108:111], v[80:83], v[20:23]
    ds_read_b128 v[100:103], v227 offset:26624
    v_mfma_f32_16x16x32_bf16 v[36:39], a[108:111], v[84:87], v[36:39]
    ds_read_b128 v[104:107], v227 offset:28672
    v_mfma_f32_16x16x32_bf16 v[32:35], a[104:107], v[84:87], v[32:35]
    ds_read_b128 v[108:111], v227 offset:30720
    s_waitcnt lgkmcnt(4)
    v_mfma_f32_16x16x32_bf16 v[24:27], a[104:107], v[88:91], v[24:27]
    buffer_load_dwordx4 v222, s[52:55], s2 offen offset:2048 lds
    v_mfma_f32_16x16x32_bf16 v[28:31], a[108:111], v[88:91], v[28:31]
    v_mfma_f32_16x16x32_bf16 v[44:47], a[108:111], v[92:95], v[44:47]
    buffer_load_dwordx4 v223, s[52:55], s2 offen offset:3072 lds
    v_mfma_f32_16x16x32_bf16 v[40:43], a[104:107], v[92:95], v[40:43]
    s_xor_b32 s2, s33, 256
    s_add_u32 m0, s81, 32768
    s_waitcnt vmcnt(8)
    s_barrier
    s_waitcnt lgkmcnt(2)
    v_mfma_f32_16x16x32_bf16 v[48:51], a[104:107], v[96:99], v[48:51]
    ds_read_b128 a[112:115], v224 offset:32768
    global_load_dword v3, v3, s[22:23]
    v_mfma_f32_16x16x32_bf16 v[52:55], a[108:111], v[96:99], v[52:55]
    ds_read_b128 a[116:119], v224 offset:34816
    v_mfma_f32_16x16x32_bf16 v[68:71], a[108:111], v[100:103], v[68:71]
    ds_read_b128 v[80:83], v226 offset:49152
    v_mfma_f32_16x16x32_bf16 v[64:67], a[104:107], v[100:103], v[64:67]
    ds_read_b128 v[84:87], v226 offset:51200
    s_waitcnt lgkmcnt(4)
    v_mfma_f32_16x16x32_bf16 v[56:59], a[104:107], v[104:107], v[56:59]
    buffer_load_dwordx4 v216, s[48:51], s2 offen lds
    v_mfma_f32_16x16x32_bf16 v[60:63], a[108:111], v[104:107], v[60:63]
    ds_read_b128 v[88:91], v226 offset:53248
    v_mfma_f32_16x16x32_bf16 v[76:79], a[108:111], v[108:111], v[76:79]
    buffer_load_dwordx4 v217, s[48:51], s2 offen offset:1024 lds
    v_mfma_f32_16x16x32_bf16 v[72:75], a[104:107], v[108:111], v[72:75]
    ds_read_b128 v[92:95], v226 offset:55296
    v_xor_b32 v224, 0x10000, v224
    s_waitcnt lgkmcnt(2)
    v_mfma_f32_16x16x32_bf16 v[16:19], a[112:115], v[80:83], v[16:19]
    ds_read_b128 a[120:123], v225 offset:32768
    v_mfma_f32_16x16x32_bf16 v[20:23], a[116:119], v[80:83], v[20:23]
    ds_read_b128 v[96:99], v226 offset:57344
    v_mfma_f32_16x16x32_bf16 v[36:39], a[116:119], v[84:87], v[36:39]
    ds_read_b128 v[100:103], v226 offset:59392
    v_mfma_f32_16x16x32_bf16 v[32:35], a[112:115], v[84:87], v[32:35]
    ds_read_b128 v[104:107], v226 offset:61440
    s_waitcnt lgkmcnt(4)
    v_mfma_f32_16x16x32_bf16 v[24:27], a[112:115], v[88:91], v[24:27]
    v_mfma_f32_16x16x32_bf16 v[28:31], a[116:119], v[88:91], v[28:31]
    ds_read_b128 v[108:111], v226 offset:63488
    v_mfma_f32_16x16x32_bf16 v[44:47], a[116:119], v[92:95], v[44:47]
    v_mfma_f32_16x16x32_bf16 v[40:43], a[112:115], v[92:95], v[40:43]
    v_xor_b32 v226, 0x10000, v226
    s_waitcnt lgkmcnt(2)
    v_mfma_f32_16x16x32_bf16 v[48:51], a[112:115], v[96:99], v[48:51]
    ds_read_b128 a[124:127], v225 offset:34816
    v_mfma_f32_16x16x32_bf16 v[52:55], a[116:119], v[96:99], v[52:55]
    ds_read_b128 v[80:83], v227 offset:49152
    v_mfma_f32_16x16x32_bf16 v[68:71], a[116:119], v[100:103], v[68:71]
    ds_read_b128 v[84:87], v227 offset:51200
    v_mfma_f32_16x16x32_bf16 v[64:67], a[112:115], v[100:103], v[64:67]
    ds_read_b128 v[88:91], v227 offset:53248
    s_waitcnt lgkmcnt(4)
    v_mfma_f32_16x16x32_bf16 v[56:59], a[112:115], v[104:107], v[56:59]
    v_mfma_f32_16x16x32_bf16 v[60:63], a[116:119], v[104:107], v[60:63]
    ds_read_b128 v[92:95], v227 offset:55296
    v_mfma_f32_16x16x32_bf16 v[76:79], a[116:119], v[108:111], v[76:79]
    v_mfma_f32_16x16x32_bf16 v[72:75], a[112:115], v[108:111], v[72:75]
    v_xor_b32 v225, 0x10000, v225
    s_waitcnt lgkmcnt(2)
    v_mfma_f32_16x16x32_bf16 v[16:19], a[120:123], v[80:83], v[16:19]
    ds_read_b128 v[96:99], v227 offset:57344
    v_mfma_f32_16x16x32_bf16 v[20:23], a[124:127], v[80:83], v[20:23]
    ds_read_b128 v[100:103], v227 offset:59392
    v_mfma_f32_16x16x32_bf16 v[36:39], a[124:127], v[84:87], v[36:39]
    ds_read_b128 v[104:107], v227 offset:61440
    v_mfma_f32_16x16x32_bf16 v[32:35], a[120:123], v[84:87], v[32:35]
    ds_read_b128 v[108:111], v227 offset:63488
    s_waitcnt lgkmcnt(4)
    v_mfma_f32_16x16x32_bf16 v[24:27], a[120:123], v[88:91], v[24:27]
    v_mfma_f32_16x16x32_bf16 v[28:31], a[124:127], v[88:91], v[28:31]
    v_xor_b32 v227, 0x10000, v227
    v_mfma_f32_16x16x32_bf16 v[44:47], a[124:127], v[92:95], v[44:47]
    v_mfma_f32_16x16x32_bf16 v[40:43], a[120:123], v[92:95], v[40:43]
    s_waitcnt lgkmcnt(0)
    v_mfma_f32_16x16x32_bf16 v[48:51], a[120:123], v[96:99], v[48:51]
    v_mfma_f32_16x16x32_bf16 v[52:55], a[124:127], v[96:99], v[52:55]
    v_mfma_f32_16x16x32_bf16 v[68:71], a[124:127], v[100:103], v[68:71]
    v_mfma_f32_16x16x32_bf16 v[64:67], a[120:123], v[100:103], v[64:67]
    v_mfma_f32_16x16x32_bf16 v[56:59], a[120:123], v[104:107], v[56:59]
    v_mfma_f32_16x16x32_bf16 v[60:63], a[124:127], v[104:107], v[60:63]
    v_mfma_f32_16x16x32_bf16 v[76:79], a[124:127], v[108:111], v[76:79]
    v_mfma_f32_16x16x32_bf16 v[72:75], a[120:123], v[108:111], v[72:75]
    v_pk_fma_f32 v[112:113], v[16:17], v[144:145], v[18:19] op_sel_hi:[1,0,1]
    v_pk_fma_f32 v[114:115], v[24:25], v[144:145], v[26:27] op_sel_hi:[1,0,1]
    v_pk_fma_f32 v[112:113], v[24:25], v[144:145], v[112:113] op_sel:[0,1,0]
    v_pk_fma_f32 v[114:115], v[16:17], v[144:145], v[114:115] op_sel:[0,1,0] neg_lo:[0,1,0] neg_hi:[0,1,0]
    v_pk_fma_f32 v[116:117], v[32:33], v[146:147], v[34:35] op_sel_hi:[1,0,1]
    v_pk_fma_f32 v[118:119], v[40:41], v[146:147], v[42:43] op_sel_hi:[1,0,1]
    v_pk_fma_f32 v[116:117], v[40:41], v[146:147], v[116:117] op_sel:[0,1,0]
    v_pk_fma_f32 v[118:119], v[32:33], v[146:147], v[118:119] op_sel:[0,1,0] neg_lo:[0,1,0] neg_hi:[0,1,0]
    v_pk_fma_f32 v[120:121], v[48:49], v[148:149], v[50:51] op_sel_hi:[1,0,1]
    v_pk_fma_f32 v[122:123], v[56:57], v[148:149], v[58:59] op_sel_hi:[1,0,1]
    v_pk_fma_f32 v[120:121], v[56:57], v[148:149], v[120:121] op_sel:[0,1,0]
    v_pk_fma_f32 v[122:123], v[48:49], v[148:149], v[122:123] op_sel:[0,1,0] neg_lo:[0,1,0] neg_hi:[0,1,0]
    v_pk_fma_f32 v[124:125], v[64:65], v[150:151], v[66:67] op_sel_hi:[1,0,1]
    v_pk_fma_f32 v[126:127], v[72:73], v[150:151], v[74:75] op_sel_hi:[1,0,1]
    v_pk_fma_f32 v[124:125], v[72:73], v[150:151], v[124:125] op_sel:[0,1,0]
    v_pk_fma_f32 v[126:127], v[64:65], v[150:151], v[126:127] op_sel:[0,1,0] neg_lo:[0,1,0] neg_hi:[0,1,0]
    v_pk_fma_f32 v[128:129], v[112:113], v[144:145], v[20:21] op_sel_hi:[1,0,1]
    v_pk_fma_f32 v[130:131], v[114:115], v[144:145], v[28:29] op_sel_hi:[1,0,1]
    v_pk_fma_f32 v[128:129], v[114:115], v[144:145], v[128:129] op_sel:[0,1,0]
    v_pk_fma_f32 v[130:131], v[112:113], v[144:145], v[130:131] op_sel:[0,1,0] neg_lo:[0,1,0] neg_hi:[0,1,0]
    v_pk_fma_f32 v[132:133], v[116:117], v[146:147], v[36:37] op_sel_hi:[1,0,1]
    v_pk_fma_f32 v[134:135], v[118:119], v[146:147], v[44:45] op_sel_hi:[1,0,1]
    v_pk_fma_f32 v[132:133], v[118:119], v[146:147], v[132:133] op_sel:[0,1,0]
    v_pk_fma_f32 v[134:135], v[116:117], v[146:147], v[134:135] op_sel:[0,1,0] neg_lo:[0,1,0] neg_hi:[0,1,0]
    v_pk_fma_f32 v[136:137], v[120:121], v[148:149], v[52:53] op_sel_hi:[1,0,1]
    v_pk_fma_f32 v[138:139], v[122:123], v[148:149], v[60:61] op_sel_hi:[1,0,1]
    v_pk_fma_f32 v[136:137], v[122:123], v[148:149], v[136:137] op_sel:[0,1,0]
    v_pk_fma_f32 v[138:139], v[120:121], v[148:149], v[138:139] op_sel:[0,1,0] neg_lo:[0,1,0] neg_hi:[0,1,0]
    v_pk_fma_f32 v[140:141], v[124:125], v[150:151], v[68:69] op_sel_hi:[1,0,1]
    v_pk_fma_f32 v[142:143], v[126:127], v[150:151], v[76:77] op_sel_hi:[1,0,1]
    v_pk_fma_f32 v[140:141], v[126:127], v[150:151], v[140:141] op_sel:[0,1,0]
    v_pk_fma_f32 v[142:143], v[124:125], v[150:151], v[142:143] op_sel:[0,1,0] neg_lo:[0,1,0] neg_hi:[0,1,0]
    v_pk_fma_f32 v[112:113], v[128:129], v[144:145], v[22:23] op_sel_hi:[1,0,1]
    v_pk_fma_f32 v[114:115], v[130:131], v[144:145], v[30:31] op_sel_hi:[1,0,1]
    v_pk_fma_f32 v[112:113], v[130:131], v[144:145], v[112:113] op_sel:[0,1,0]
    v_pk_fma_f32 v[114:115], v[128:129], v[144:145], v[114:115] op_sel:[0,1,0] neg_lo:[0,1,0] neg_hi:[0,1,0]
    v_pk_fma_f32 v[116:117], v[132:133], v[146:147], v[38:39] op_sel_hi:[1,0,1]
    v_pk_fma_f32 v[118:119], v[134:135], v[146:147], v[46:47] op_sel_hi:[1,0,1]
    v_pk_fma_f32 v[116:117], v[134:135], v[146:147], v[116:117] op_sel:[0,1,0]
    v_pk_fma_f32 v[118:119], v[132:133], v[146:147], v[118:119] op_sel:[0,1,0] neg_lo:[0,1,0] neg_hi:[0,1,0]
    v_pk_fma_f32 v[120:121], v[136:137], v[148:149], v[54:55] op_sel_hi:[1,0,1]
    v_pk_fma_f32 v[122:123], v[138:139], v[148:149], v[62:63] op_sel_hi:[1,0,1]
    v_pk_fma_f32 v[120:121], v[138:139], v[148:149], v[120:121] op_sel:[0,1,0]
    v_pk_fma_f32 v[122:123], v[136:137], v[148:149], v[122:123] op_sel:[0,1,0] neg_lo:[0,1,0] neg_hi:[0,1,0]
    v_pk_fma_f32 v[124:125], v[140:141], v[150:151], v[70:71] op_sel_hi:[1,0,1]
    v_pk_fma_f32 v[126:127], v[142:143], v[150:151], v[78:79] op_sel_hi:[1,0,1]
    v_pk_fma_f32 v[124:125], v[142:143], v[150:151], v[124:125] op_sel:[0,1,0]
    v_pk_fma_f32 v[126:127], v[140:141], v[150:151], v[126:127] op_sel:[0,1,0] neg_lo:[0,1,0] neg_hi:[0,1,0]
    v_fma_f32 v128, v176, v112, v113
    v_fma_f32 v128, v177, v114, v128
    v_fma_f32 v130, v178, v116, v117
    v_fma_f32 v130, v179, v118, v130
    v_fma_f32 v132, v180, v120, v121
    v_fma_f32 v132, v181, v122, v132
    v_fma_f32 v134, v182, v124, v125
    v_fma_f32 v134, v183, v126, v134
    v_fma_f32 v129, v177, v112, -v115
    v_fma_f32 v129, -v176, v114, v129
    v_fma_f32 v131, v179, v116, -v119
    v_fma_f32 v131, -v178, v118, v131
    v_fma_f32 v133, v181, v120, -v123
    v_fma_f32 v133, -v180, v122, v133
    v_fma_f32 v135, v183, v124, -v127
    v_fma_f32 v135, -v182, v126, v135
    v_permlane32_swap_b32 v128, v132
    v_permlane32_swap_b32 v130, v134
    v_permlane32_swap_b32 v129, v133
    v_permlane32_swap_b32 v131, v135
    v_permlane16_swap_b32 v128, v130
    v_permlane16_swap_b32 v132, v134
    v_permlane16_swap_b32 v129, v131
    v_permlane16_swap_b32 v133, v135
    v_pk_fma_f32 v[4:5], v[128:129], v[188:189], v[130:131] op_sel_hi:[0,1,1]
    v_pk_fma_f32 v[4:5], v[128:129], v[188:189], v[4:5] op_sel:[1,1,0] op_sel_hi:[1,0,1] neg_lo:[0,1,0]
    v_pk_fma_f32 v[6:7], v[4:5], v[188:189], v[132:133] op_sel_hi:[0,1,1]
    v_pk_fma_f32 v[6:7], v[4:5], v[188:189], v[6:7] op_sel:[1,1,0] op_sel_hi:[1,0,1] neg_lo:[0,1,0]
    v_pk_fma_f32 v[8:9], v[6:7], v[188:189], v[134:135] op_sel_hi:[0,1,1]
    v_pk_fma_f32 v[8:9], v[6:7], v[188:189], v[8:9] op_sel:[1,1,0] op_sel_hi:[1,0,1] neg_lo:[0,1,0]
    ds_write_b64 v245, v[8:9]
    s_waitcnt lgkmcnt(0)
    s_barrier
    ds_read_b64 v[80:81], v244 offset:0
    ds_read_b64 v[82:83], v244 offset:512
    ds_read_b64 v[84:85], v244 offset:1024
    ds_read_b64 v[86:87], v244 offset:1536
    s_cmp_eq_u32 s60, 0
    s_waitcnt lgkmcnt(2)
    v_pk_fma_f32 v[88:89], v[80:81], v[190:191], v[82:83] op_sel_hi:[0,1,1]
    v_pk_fma_f32 v[88:89], v[80:81], v[190:191], v[88:89] op_sel:[1,1,0] op_sel_hi:[1,0,1] neg_lo:[0,1,0]
    s_waitcnt lgkmcnt(1)
    v_pk_fma_f32 v[90:91], v[88:89], v[190:191], v[84:85] op_sel_hi:[0,1,1]
    v_pk_fma_f32 v[90:91], v[88:89], v[190:191], v[90:91] op_sel:[1,1,0] op_sel_hi:[1,0,1] neg_lo:[0,1,0]
    s_waitcnt lgkmcnt(0)
    v_pk_fma_f32 v[92:93], v[90:91], v[190:191], v[86:87] op_sel_hi:[0,1,1]
    v_pk_fma_f32 v[92:93], v[90:91], v[190:191], v[92:93] op_sel:[1,1,0] op_sel_hi:[1,0,1] neg_lo:[0,1,0]
    s_cbranch_scc0 L_nopub
    v_mov_b32 v172, v92
    v_mov_b32 v174, v93
    buffer_store_dwordx4 v[172:175], v13, s[44:47], s74 offen sc1
L_nopub:
    s_xor_b32 s2, s32, 131072
    s_add_u32 m0, s81, 65536
    s_nop 0
    buffer_load_dwordx4 v220, s[52:55], s2 offen lds
    buffer_load_dwordx4 v221, s[52:55], s2 offen offset:1024 lds
    v_mov_b32 v4, 0
    v_mov_b32 v5, 0
    s_cmp_eq_u32 s60, 1
    s_cselect_b64 exec, -1, 0
    v_mov_b64 v[4:5], v[80:81]
    s_cmp_eq_u32 s60, 2
    s_cselect_b64 exec, -1, 0
    v_mov_b64 v[4:5], v[88:89]
    s_cmp_eq_u32 s60, 3
    s_cselect_b64 exec, -1, 0
    v_mov_b64_e64 v[4:5], v[90:91]
    s_mov_b64 exec, -1
    v_pk_mul_f32 v[94:95], v[4:5], v[186:187] op_sel_hi:[0,1]
    v_pk_fma_f32 v[94:95], v[4:5], v[186:187], v[94:95] op_sel:[1,1,0] op_sel_hi:[1,0,1] neg_lo:[0,1,0]
    v_pk_fma_f32 v[128:129], v[4:5], v[188:189], v[128:129] op_sel_hi:[0,1,1]
    v_pk_fma_f32 v[128:129], v[4:5], v[188:189], v[128:129] op_sel:[1,1,0] op_sel_hi:[1,0,1] neg_lo:[0,1,0]
    v_pk_mul_f32 v[96:97], v[128:129], v[186:187] op_sel_hi:[0,1]
    v_pk_fma_f32 v[96:97], v[128:129], v[186:187], v[96:97] op_sel:[1,1,0] op_sel_hi:[1,0,1] neg_lo:[0,1,0]
    v_pk_fma_f32 v[130:131], v[128:129], v[188:189], v[130:131] op_sel_hi:[0,1,1]
    v_pk_fma_f32 v[130:131], v[128:129], v[188:189], v[130:131] op_sel:[1,1,0] op_sel_hi:[1,0,1] neg_lo:[0,1,0]
    v_pk_mul_f32 v[98:99], v[130:131], v[186:187] op_sel_hi:[0,1]
    v_pk_fma_f32 v[98:99], v[130:131], v[186:187], v[98:99] op_sel:[1,1,0] op_sel_hi:[1,0,1] neg_lo:[0,1,0]
    v_pk_fma_f32 v[132:133], v[130:131], v[188:189], v[132:133] op_sel_hi:[0,1,1]
    v_pk_fma_f32 v[132:133], v[130:131], v[188:189], v[132:133] op_sel:[1,1,0] op_sel_hi:[1,0,1] neg_lo:[0,1,0]
    v_pk_mul_f32 v[100:101], v[132:133], v[186:187] op_sel_hi:[0,1]
    v_pk_fma_f32 v[100:101], v[132:133], v[186:187], v[100:101] op_sel:[1,1,0] op_sel_hi:[1,0,1] neg_lo:[0,1,0]
    v_mov_b32 v8, 0x3f80
    v_mov_b32 v9, 0
    v_and_b32 v10, 48, v13
    v_mov_b64 v[104:105], 0
    v_mov_b64 v[106:107], 0
    v_mov_b64 v[108:109], 0
    v_mov_b64 v[110:111], 0
    v_lshlrev_b64 v[8:9], v10, v[8:9]
    s_mov_b32 exec_lo, 0xf00000f
    s_mov_b32 exec_hi, 0x0
    v_mov_b64 v[104:105], v[8:9]
    s_mov_b32 exec_lo, 0xf00000f0
    s_mov_b32 exec_hi, 0x0
    v_mov_b64 v[106:107], v[8:9]
    s_mov_b32 exec_lo, 0x0
    s_mov_b32 exec_hi, 0xf00000f
    v_mov_b64 v[108:109], v[8:9]
    s_mov_b32 exec_lo, 0x0
    s_mov_b32 exec_hi, 0xf00000f0
    v_mov_b64_e64 v[110:111], v[8:9]
    s_mov_b64 exec, -1
    v_pk_mul_f32 v[112:113], v[16:17], v[246:247] op_sel:[0,0] op_sel_hi:[0,1]
    v_pk_fma_f32 v[112:113], v[24:25], v[246:247], v[112:113] op_sel:[0,1,0] op_sel_hi:[0,0,1] neg_hi:[0,1,0]
    v_pk_mul_f32 v[114:115], v[16:17], v[246:247] op_sel:[1,0] op_sel_hi:[1,1]
    v_pk_fma_f32 v[114:115], v[24:25], v[246:247], v[114:115] op_sel:[1,1,0] op_sel_hi:[1,0,1] neg_hi:[0,1,0]
    v_pk_mul_f32 v[116:117], v[18:19], v[246:247] op_sel:[0,0] op_sel_hi:[0,1]
    v_pk_fma_f32 v[116:117], v[26:27], v[246:247], v[116:117] op_sel:[0,1,0] op_sel_hi:[0,0,1] neg_hi:[0,1,0]
    v_pk_mul_f32 v[118:119], v[18:19], v[246:247] op_sel:[1,0] op_sel_hi:[1,1]
    v_pk_fma_f32 v[118:119], v[26:27], v[246:247], v[118:119] op_sel:[1,1,0] op_sel_hi:[1,0,1] neg_hi:[0,1,0]
    v_pk_mul_f32 v[120:121], v[20:21], v[246:247] op_sel:[0,0] op_sel_hi:[0,1]
    v_pk_fma_f32 v[120:121], v[28:29], v[246:247], v[120:121] op_sel:[0,1,0] op_sel_hi:[0,0,1] neg_hi:[0,1,0]
    buffer_load_dwordx4 v222, s[52:55], s2 offen offset:2048 lds
    v_pk_mul_f32 v[122:123], v[20:21], v[246:247] op_sel:[1,0] op_sel_hi:[1,1]
    v_pk_fma_f32 v[122:123], v[28:29], v[246:247], v[122:123] op_sel:[1,1,0] op_sel_hi:[1,0,1] neg_hi:[0,1,0]
    v_pk_mul_f32 v[124:125], v[22:23], v[246:247] op_sel:[0,0] op_sel_hi:[0,1]
    v_pk_fma_f32 v[124:125], v[30:31], v[246:247], v[124:125] op_sel:[0,1,0] op_sel_hi:[0,0,1] neg_hi:[0,1,0]
    v_pk_mul_f32 v[126:127], v[22:23], v[246:247] op_sel:[1,0] op_sel_hi:[1,1]
    v_pk_fma_f32 v[126:127], v[30:31], v[246:247], v[126:127] op_sel:[1,1,0] op_sel_hi:[1,0,1] neg_hi:[0,1,0]
    v_pk_mul_f32 v[128:129], v[32:33], v[248:249] op_sel:[0,0] op_sel_hi:[0,1]
    v_pk_fma_f32 v[128:129], v[40:41], v[248:249], v[128:129] op_sel:[0,1,0] op_sel_hi:[0,0,1] neg_hi:[0,1,0]
    v_pk_mul_f32 v[130:131], v[32:33], v[248:249] op_sel:[1,0] op_sel_hi:[1,1]
    v_pk_fma_f32 v[130:131], v[40:41], v[248:249], v[130:131] op_sel:[1,1,0] op_sel_hi:[1,0,1] neg_hi:[0,1,0]
    buffer_load_dwordx4 v223, s[52:55], s2 offen offset:3072 lds
    v_pk_mul_f32 v[132:133], v[34:35], v[248:249] op_sel:[0,0] op_sel_hi:[0,1]
    v_pk_fma_f32 v[132:133], v[42:43], v[248:249], v[132:133] op_sel:[0,1,0] op_sel_hi:[0,0,1] neg_hi:[0,1,0]
    v_pk_mul_f32 v[134:135], v[34:35], v[248:249] op_sel:[1,0] op_sel_hi:[1,1]
    v_pk_fma_f32 v[134:135], v[42:43], v[248:249], v[134:135] op_sel:[1,1,0] op_sel_hi:[1,0,1] neg_hi:[0,1,0]
    v_pk_mul_f32 v[136:137], v[36:37], v[248:249] op_sel:[0,0] op_sel_hi:[0,1]
    v_pk_fma_f32 v[136:137], v[44:45], v[248:249], v[136:137] op_sel:[0,1,0] op_sel_hi:[0,0,1] neg_hi:[0,1,0]
    v_pk_mul_f32 v[138:139], v[36:37], v[248:249] op_sel:[1,0] op_sel_hi:[1,1]
    v_pk_fma_f32 v[138:139], v[44:45], v[248:249], v[138:139] op_sel:[1,1,0] op_sel_hi:[1,0,1] neg_hi:[0,1,0]
    v_pk_mul_f32 v[140:141], v[38:39], v[248:249] op_sel:[0,0] op_sel_hi:[0,1]
    v_pk_fma_f32 v[140:141], v[46:47], v[248:249], v[140:141] op_sel:[0,1,0] op_sel_hi:[0,0,1] neg_hi:[0,1,0]
    s_add_u32 s2, s2, 32768
    s_add_u32 m0, s81, 69632
    s_nop 0
    buffer_load_dwordx4 v220, s[52:55], s2 offen lds
    v_pk_mul_f32 v[142:143], v[38:39], v[248:249] op_sel:[1,0] op_sel_hi:[1,1]
    v_pk_fma_f32 v[142:143], v[46:47], v[248:249], v[142:143] op_sel:[1,1,0] op_sel_hi:[1,0,1] neg_hi:[0,1,0]
    v_pk_mul_f32 v[144:145], v[48:49], v[250:251] op_sel:[0,0] op_sel_hi:[0,1]
    v_pk_fma_f32 v[144:145], v[56:57], v[250:251], v[144:145] op_sel:[0,1,0] op_sel_hi:[0,0,1] neg_hi:[0,1,0]
    v_pk_mul_f32 v[146:147], v[48:49], v[250:251] op_sel:[1,0] op_sel_hi:[1,1]
    v_pk_fma_f32 v[146:147], v[56:57], v[250:251], v[146:147] op_sel:[1,1,0] op_sel_hi:[1,0,1] neg_hi:[0,1,0]
    v_pk_mul_f32 v[148:149], v[50:51], v[250:251] op_sel:[0,0] op_sel_hi:[0,1]
    v_pk_fma_f32 v[148:149], v[58:59], v[250:251], v[148:149] op_sel:[0,1,0] op_sel_hi:[0,0,1] neg_hi:[0,1,0]
    v_pk_mul_f32 v[150:151], v[50:51], v[250:251] op_sel:[1,0] op_sel_hi:[1,1]
    v_pk_fma_f32 v[150:151], v[58:59], v[250:251], v[150:151] op_sel:[1,1,0] op_sel_hi:[1,0,1] neg_hi:[0,1,0]
    buffer_load_dwordx4 v221, s[52:55], s2 offen offset:1024 lds
    v_pk_mul_f32 v[152:153], v[52:53], v[250:251] op_sel:[0,0] op_sel_hi:[0,1]
    v_pk_fma_f32 v[152:153], v[60:61], v[250:251], v[152:153] op_sel:[0,1,0] op_sel_hi:[0,0,1] neg_hi:[0,1,0]
    v_pk_mul_f32 v[154:155], v[52:53], v[250:251] op_sel:[1,0] op_sel_hi:[1,1]
    v_pk_fma_f32 v[154:155], v[60:61], v[250:251], v[154:155] op_sel:[1,1,0] op_sel_hi:[1,0,1] neg_hi:[0,1,0]
    v_pk_mul_f32 v[156:157], v[54:55], v[250:251] op_sel:[0,0] op_sel_hi:[0,1]
    v_pk_fma_f32 v[156:157], v[62:63], v[250:251], v[156:157] op_sel:[0,1,0] op_sel_hi:[0,0,1] neg_hi:[0,1,0]
    v_pk_mul_f32 v[158:159], v[54:55], v[250:251] op_sel:[1,0] op_sel_hi:[1,1]
    v_pk_fma_f32 v[158:159], v[62:63], v[250:251], v[158:159] op_sel:[1,1,0] op_sel_hi:[1,0,1] neg_hi:[0,1,0]
    v_pk_mul_f32 v[160:161], v[64:65], v[252:253] op_sel:[0,0] op_sel_hi:[0,1]
    v_pk_fma_f32 v[160:161], v[72:73], v[252:253], v[160:161] op_sel:[0,1,0] op_sel_hi:[0,0,1] neg_hi:[0,1,0]
    buffer_load_dwordx4 v222, s[52:55], s2 offen offset:2048 lds
    v_pk_mul_f32 v[162:163], v[64:65], v[252:253] op_sel:[1,0] op_sel_hi:[1,1]
    v_pk_fma_f32 v[162:163], v[72:73], v[252:253], v[162:163] op_sel:[1,1,0] op_sel_hi:[1,0,1] neg_hi:[0,1,0]
    v_pk_mul_f32 v[164:165], v[66:67], v[252:253] op_sel:[0,0] op_sel_hi:[0,1]
    v_pk_fma_f32 v[164:165], v[74:75], v[252:253], v[164:165] op_sel:[0,1,0] op_sel_hi:[0,0,1] neg_hi:[0,1,0]
    v_pk_mul_f32 v[166:167], v[66:67], v[252:253] op_sel:[1,0] op_sel_hi:[1,1]
    v_pk_fma_f32 v[166:167], v[74:75], v[252:253], v[166:167] op_sel:[1,1,0] op_sel_hi:[1,0,1] neg_hi:[0,1,0]
    v_pk_mul_f32 v[168:169], v[68:69], v[252:253] op_sel:[0,0] op_sel_hi:[0,1]
    v_pk_fma_f32 v[168:169], v[76:77], v[252:253], v[168:169] op_sel:[0,1,0] op_sel_hi:[0,0,1] neg_hi:[0,1,0]
    v_pk_mul_f32 v[170:171], v[68:69], v[252:253] op_sel:[1,0] op_sel_hi:[1,1]
    v_pk_fma_f32 v[170:171], v[76:77], v[252:253], v[170:171] op_sel:[1,1,0] op_sel_hi:[1,0,1] neg_hi:[0,1,0]
    buffer_load_dwordx4 v223, s[52:55], s2 offen offset:3072 lds
    v_pk_mul_f32 v[172:173], v[70:71], v[252:253] op_sel:[0,0] op_sel_hi:[0,1]
    v_pk_fma_f32 v[172:173], v[78:79], v[252:253], v[172:173] op_sel:[0,1,0] op_sel_hi:[0,0,1] neg_hi:[0,1,0]
    v_pk_mul_f32 v[174:175], v[70:71], v[252:253] op_sel:[1,0] op_sel_hi:[1,1]
    v_pk_fma_f32 v[174:175], v[78:79], v[252:253], v[174:175] op_sel:[1,1,0] op_sel_hi:[1,0,1] neg_hi:[0,1,0]
    s_lshr_b32 s2, s76, 2
    s_add_u32 m0, s2, 151552
    s_nop 0
    buffer_load_dwordx4 v13, s[28:31], 0 offen lds
    buffer_load_dwordx4 v[16:19], v13, s[44:47], s72 offen sc1
    buffer_load_dwordx4 v[20:23], v13, s[44:47], s73 offen sc1
    buffer_load_dwordx4 v[24:27], v13, s[44:47], s75 offen sc1
    buffer_load_dwordx4 v[28:31], v13, s[44:47], s71 offen sc1
    s_waitcnt vmcnt(16)
    s_barrier
    s_nop 0
    ds_read_b64_tr_b16 a[128:129], v234 offset:0
    ds_read_b64_tr_b16 a[130:131], v234 offset:1024
    ds_read_b64_tr_b16 a[132:133], v235 offset:0
    ds_read_b64_tr_b16 a[134:135], v235 offset:1024
    ds_read_b64_tr_b16 a[136:137], v234 offset:2048
    ds_read_b64_tr_b16 a[138:139], v234 offset:3072
    ds_read_b64_tr_b16 a[140:141], v235 offset:2048
    ds_read_b64_tr_b16 a[142:143], v235 offset:3072
    ds_read_b64_tr_b16 a[144:145], v234 offset:4096
    ds_read_b64_tr_b16 a[146:147], v234 offset:5120
    ds_read_b64_tr_b16 a[148:149], v235 offset:4096
    ds_read_b64_tr_b16 a[150:151], v235 offset:5120
    ds_read_b64_tr_b16 a[152:153], v234 offset:6144
    ds_read_b64_tr_b16 a[154:155], v234 offset:7168
    ds_read_b64_tr_b16 a[156:157], v235 offset:6144
    ds_read_b64_tr_b16 a[158:159], v235 offset:7168
    ds_read_b64_tr_b16 a[160:161], v234 offset:8192
    ds_read_b64_tr_b16 a[162:163], v234 offset:9216
    ds_read_b64_tr_b16 a[164:165], v235 offset:8192
    ds_read_b64_tr_b16 a[166:167], v235 offset:9216
    ds_read_b64_tr_b16 a[168:169], v234 offset:10240
    ds_read_b64_tr_b16 a[170:171], v234 offset:11264
    ds_read_b64_tr_b16 a[172:173], v235 offset:10240
    ds_read_b64_tr_b16 a[174:175], v235 offset:11264
    ds_read_b64_tr_b16 a[176:177], v234 offset:12288
    ds_read_b64_tr_b16 a[178:179], v234 offset:13312
    ds_read_b64_tr_b16 a[180:181], v235 offset:12288
    ds_read_b64_tr_b16 a[182:183], v235 offset:13312
    ds_read_b64_tr_b16 a[184:185], v234 offset:14336
    ds_read_b64_tr_b16 a[186:187], v234 offset:15360
    ds_read_b64_tr_b16 a[188:189], v235 offset:14336
    ds_read_b64_tr_b16 a[190:191], v235 offset:15360
    v_add_u32 v234, 0x10000, v234
    v_add_u32 v235, 0x10000, v235
    s_waitcnt vmcnt(0)
    v_pk_mul_f32 v[6:7], v[16:17], v[192:193] op_sel_hi:[0,1]
    v_pk_fma_f32 v[6:7], v[18:19], v[192:193], v[6:7] op_sel:[0,1,0] op_sel_hi:[0,0,1] neg_lo:[0,1,0]
    v_pk_fma_f32 v[6:7], v[20:21], v[194:195], v[6:7] op_sel_hi:[0,1,1]
    v_pk_fma_f32 v[6:7], v[22:23], v[194:195], v[6:7] op_sel:[0,1,0] op_sel_hi:[0,0,1] neg_lo:[0,1,0]
    v_pk_fma_f32 v[6:7], v[24:25], v[196:197], v[6:7] op_sel_hi:[0,1,1]
    v_pk_fma_f32 v[6:7], v[26:27], v[196:197], v[6:7] op_sel:[0,1,0] op_sel_hi:[0,0,1] neg_lo:[0,1,0]
    v_pk_fma_f32 v[6:7], v[28:29], v[198:199], v[6:7] op_sel_hi:[0,1,1]
    v_pk_fma_f32 v[6:7], v[30:31], v[198:199], v[6:7] op_sel:[0,1,0] op_sel_hi:[0,0,1] neg_lo:[0,1,0]
    ds_write_b64 v245, v[6:7] offset:2048
    v_xor_b32 v4, s84, v17
    v_bitop3_b32 v4, v4, v19, s84 bitop3:0xf6
    v_bitop3_b32 v4, v4, v21, s85 bitop3:0xf6
    v_bitop3_b32 v4, v4, v23, s85 bitop3:0xf6
    v_bitop3_b32 v4, v4, v25, s82 bitop3:0xf6
    v_bitop3_b32 v4, v4, v27, s82 bitop3:0xf6
    v_bitop3_b32 v4, v4, v29, s83 bitop3:0xf6
    v_bitop3_b32 v4, v4, v31, s83 bitop3:0xf6
    v_cmp_ne_u32 vcc, 0, v4
    s_nop 0
    s_cbranch_vccz L_pagg_x
    s_mov_b32 s78, 131072
L_pagg:
    buffer_load_dwordx4 v[16:19], v13, s[44:47], s72 offen sc1
    buffer_load_dwordx4 v[20:23], v13, s[44:47], s73 offen sc1
    buffer_load_dwordx4 v[24:27], v13, s[44:47], s75 offen sc1
    buffer_load_dwordx4 v[28:31], v13, s[44:47], s71 offen sc1
    s_waitcnt vmcnt(0)
    v_pk_mul_f32 v[6:7], v[16:17], v[192:193] op_sel_hi:[0,1]
    v_pk_fma_f32 v[6:7], v[18:19], v[192:193], v[6:7] op_sel:[0,1,0] op_sel_hi:[0,0,1] neg_lo:[0,1,0]
    v_pk_fma_f32 v[6:7], v[20:21], v[194:195], v[6:7] op_sel_hi:[0,1,1]
    v_pk_fma_f32 v[6:7], v[22:23], v[194:195], v[6:7] op_sel:[0,1,0] op_sel_hi:[0,0,1] neg_lo:[0,1,0]
    v_pk_fma_f32 v[6:7], v[24:25], v[196:197], v[6:7] op_sel_hi:[0,1,1]
    v_pk_fma_f32 v[6:7], v[26:27], v[196:197], v[6:7] op_sel:[0,1,0] op_sel_hi:[0,0,1] neg_lo:[0,1,0]
    v_pk_fma_f32 v[6:7], v[28:29], v[198:199], v[6:7] op_sel_hi:[0,1,1]
    v_pk_fma_f32 v[6:7], v[30:31], v[198:199], v[6:7] op_sel:[0,1,0] op_sel_hi:[0,0,1] neg_lo:[0,1,0]
    ds_write_b64 v245, v[6:7] offset:2048
    v_xor_b32_e64 v4, s84, v17
    v_bitop3_b32 v4, v4, v19, s84 bitop3:0xf6
    v_bitop3_b32 v4, v4, v21, s85 bitop3:0xf6
    v_bitop3_b32 v4, v4, v23, s85 bitop3:0xf6
    v_bitop3_b32 v4, v4, v25, s82 bitop3:0xf6
    v_bitop3_b32 v4, v4, v27, s82 bitop3:0xf6
    v_bitop3_b32 v4, v4, v29, s83 bitop3:0xf6
    v_bitop3_b32 v4, v4, v31, s83 bitop3:0xf6
    v_cmp_ne_u32 vcc, 0, v4
    s_sub_u32 s78, s78, 1
    s_cbranch_scc1 L_pagg_x
    s_cbranch_vccnz L_pagg
L_pagg_x:
    s_waitcnt lgkmcnt(0)
    s_barrier
    ds_read_b64 v[80:81], v244 offset:2048
    ds_read_b64 v[82:83], v244 offset:2560
    ds_read_b64 v[84:85], v244 offset:3072
    ds_read_b64 v[86:87], v244 offset:3584
    s_xor_b32 s2, s33, 0
    s_add_u32 m0, s81, 0
    s_nop 0
    buffer_load_dwordx4 v216, s[48:51], s2 offen lds
    buffer_load_dwordx4 v217, s[48:51], s2 offen offset:1024 lds
    buffer_load_dwordx4 v218, s[48:51], s2 offen offset:2048 lds
    buffer_load_dwordx4 v219, s[48:51], s2 offen offset:3072 lds
    s_waitcnt lgkmcnt(0)
    v_pk_add_f32 v[80:81], v[80:81], v[82:83]
    v_pk_add_f32 v[84:85], v[84:85], v[86:87]
    v_pk_add_f32 v[80:81], v[80:81], v[84:85]
    v_pk_fma_f32 v[94:95], v[80:81], v[200:201], v[94:95] op_sel_hi:[0,1,1]
    v_pk_fma_f32 v[94:95], v[80:81], v[200:201], v[94:95] op_sel:[1,1,0] op_sel_hi:[1,0,1] neg_lo:[0,1,0]
    v_pk_fma_f32 v[96:97], v[80:81], v[202:203], v[96:97] op_sel_hi:[0,1,1]
    v_pk_fma_f32 v[96:97], v[80:81], v[202:203], v[96:97] op_sel:[1,1,0] op_sel_hi:[1,0,1] neg_lo:[0,1,0]
    v_pk_fma_f32 v[98:99], v[80:81], v[204:205], v[98:99] op_sel_hi:[0,1,1]
    v_pk_fma_f32 v[98:99], v[80:81], v[204:205], v[98:99] op_sel:[1,1,0] op_sel_hi:[1,0,1] neg_lo:[0,1,0]
    v_pk_fma_f32 v[100:101], v[80:81], v[206:207], v[100:101] op_sel_hi:[0,1,1]
    v_pk_fma_f32 v[100:101], v[80:81], v[206:207], v[100:101] op_sel:[1,1,0] op_sel_hi:[1,0,1] neg_lo:[0,1,0]
    v_permlane32_swap_b32 v94, v98
    s_nop 0
    v_permlane32_swap_b32 v96, v100
    v_permlane32_swap_b32 v95, v99
    v_permlane32_swap_b32 v97, v101
    v_permlane16_swap_b32 v94, v96
    v_permlane16_swap_b32 v98, v100
    v_permlane16_swap_b32 v95, v97
    v_permlane16_swap_b32 v99, v101
    s_nop 0
    v_pk_fma_f32 v[112:113], v[94:95], v[176:177], v[112:113] op_sel_hi:[0,1,1]
    v_pk_fma_f32 v[112:113], v[94:95], v[176:177], v[112:113] op_sel:[1,1,0] op_sel_hi:[1,0,1] neg_lo:[0,1,0]
    v_pk_fma_f32 v[114:115], v[112:113], v[176:177], v[114:115] op_sel_hi:[0,1,1]
    v_pk_fma_f32 v[114:115], v[112:113], v[176:177], v[114:115] op_sel:[1,1,0] op_sel_hi:[1,0,1] neg_lo:[0,1,0]
    v_pk_fma_f32 v[116:117], v[114:115], v[176:177], v[116:117] op_sel_hi:[0,1,1]
    v_pk_fma_f32 v[116:117], v[114:115], v[176:177], v[116:117] op_sel:[1,1,0] op_sel_hi:[1,0,1] neg_lo:[0,1,0]
    v_pk_fma_f32 v[118:119], v[116:117], v[176:177], v[118:119] op_sel_hi:[0,1,1]
    v_pk_fma_f32 v[118:119], v[116:117], v[176:177], v[118:119] op_sel:[1,1,0] op_sel_hi:[1,0,1] neg_lo:[0,1,0]
    v_pk_fma_f32 v[120:121], v[118:119], v[176:177], v[120:121] op_sel_hi:[0,1,1]
    v_pk_fma_f32 v[120:121], v[118:119], v[176:177], v[120:121] op_sel:[1,1,0] op_sel_hi:[1,0,1] neg_lo:[0,1,0]
    v_pk_fma_f32 v[122:123], v[120:121], v[176:177], v[122:123] op_sel_hi:[0,1,1]
    v_pk_fma_f32 v[122:123], v[120:121], v[176:177], v[122:123] op_sel:[1,1,0] op_sel_hi:[1,0,1] neg_lo:[0,1,0]
    v_pk_fma_f32 v[124:125], v[122:123], v[176:177], v[124:125] op_sel_hi:[0,1,1]
    v_pk_fma_f32 v[124:125], v[122:123], v[176:177], v[124:125] op_sel:[1,1,0] op_sel_hi:[1,0,1] neg_lo:[0,1,0]
    v_pk_fma_f32 v[126:127], v[124:125], v[176:177], v[126:127] op_sel_hi:[0,1,1]
    v_pk_fma_f32 v[126:127], v[124:125], v[176:177], v[126:127] op_sel:[1,1,0] op_sel_hi:[1,0,1] neg_lo:[0,1,0]
    v_pk_fma_f32 v[128:129], v[96:97], v[178:179], v[128:129] op_sel_hi:[0,1,1]
    v_pk_fma_f32 v[128:129], v[96:97], v[178:179], v[128:129] op_sel:[1,1,0] op_sel_hi:[1,0,1] neg_lo:[0,1,0]
    v_pk_fma_f32 v[130:131], v[128:129], v[178:179], v[130:131] op_sel_hi:[0,1,1]
    v_pk_fma_f32 v[130:131], v[128:129], v[178:179], v[130:131] op_sel:[1,1,0] op_sel_hi:[1,0,1] neg_lo:[0,1,0]
    v_pk_fma_f32 v[132:133], v[130:131], v[178:179], v[132:133] op_sel_hi:[0,1,1]
    v_pk_fma_f32 v[132:133], v[130:131], v[178:179], v[132:133] op_sel:[1,1,0] op_sel_hi:[1,0,1] neg_lo:[0,1,0]
    v_pk_fma_f32 v[134:135], v[132:133], v[178:179], v[134:135] op_sel_hi:[0,1,1]
    v_pk_fma_f32 v[134:135], v[132:133], v[178:179], v[134:135] op_sel:[1,1,0] op_sel_hi:[1,0,1] neg_lo:[0,1,0]
    v_pk_fma_f32 v[136:137], v[134:135], v[178:179], v[136:137] op_sel_hi:[0,1,1]
    v_pk_fma_f32 v[136:137], v[134:135], v[178:179], v[136:137] op_sel:[1,1,0] op_sel_hi:[1,0,1] neg_lo:[0,1,0]
    v_pk_fma_f32 v[138:139], v[136:137], v[178:179], v[138:139] op_sel_hi:[0,1,1]
    v_pk_fma_f32 v[138:139], v[136:137], v[178:179], v[138:139] op_sel:[1,1,0] op_sel_hi:[1,0,1] neg_lo:[0,1,0]
    v_pk_fma_f32 v[140:141], v[138:139], v[178:179], v[140:141] op_sel_hi:[0,1,1]
    v_pk_fma_f32 v[140:141], v[138:139], v[178:179], v[140:141] op_sel:[1,1,0] op_sel_hi:[1,0,1] neg_lo:[0,1,0]
    v_pk_fma_f32 v[142:143], v[140:141], v[178:179], v[142:143] op_sel_hi:[0,1,1]
    v_pk_fma_f32 v[142:143], v[140:141], v[178:179], v[142:143] op_sel:[1,1,0] op_sel_hi:[1,0,1] neg_lo:[0,1,0]
    v_cvt_pk_bf16_f32 v16, v112, v114
    v_cvt_pk_bf16_f32 v17, v116, v118
    v_cvt_pk_bf16_f32 v18, v120, v122
    v_cvt_pk_bf16_f32 v19, v124, v126
    v_cvt_pk_bf16_f32 v20, v128, v130
    v_cvt_pk_bf16_f32 v21, v132, v134
    v_mfma_f32_16x16x32_bf16 v[48:51], v[16:19], v[104:107], 0
    v_cvt_pk_bf16_f32 v22, v136, v138
    v_cvt_pk_bf16_f32 v23, v140, v142
    v_mfma_f32_16x16x32_bf16 v[56:59], v[16:19], v[108:111], 0
    v_cvt_pk_bf16_f32 v24, v113, v115
    v_cvt_pk_bf16_f32 v25, v117, v119
    v_mfma_f32_16x16x32_bf16 v[52:55], v[20:23], v[104:107], 0
    v_cvt_pk_bf16_f32 v26, v121, v123
    v_cvt_pk_bf16_f32 v27, v125, v127
    v_mfma_f32_16x16x32_bf16 v[60:63], v[20:23], v[108:111], 0
    v_cvt_pk_bf16_f32 v28, v129, v131
    v_cvt_pk_bf16_f32 v29, v133, v135
    v_mfma_f32_16x16x32_bf16 v[64:67], v[24:27], v[104:107], 0
    v_cvt_pk_bf16_f32 v30, v137, v139
    v_cvt_pk_bf16_f32 v31, v141, v143
    v_mfma_f32_16x16x32_bf16 v[72:75], v[24:27], v[108:111], 0
    s_nop 0
    v_mfma_f32_16x16x32_bf16 v[68:71], v[28:31], v[104:107], 0
    v_mfma_f32_16x16x32_bf16 v[76:79], v[28:31], v[108:111], 0
    v_cvt_pk_bf16_f32 v16, v48, v49
    v_cvt_pk_bf16_f32 v17, v50, v51
    v_cvt_pk_bf16_f32 v18, v52, v53
    v_cvt_pk_bf16_f32 v19, v54, v55
    buffer_store_dwordx4 v[16:19], v232, s[44:47], s101 offen offset:0 sc1
    v_cvt_pk_bf16_f32 v20, v56, v57
    v_cvt_pk_bf16_f32 v21, v58, v59
    v_cvt_pk_bf16_f32 v22, v60, v61
    v_cvt_pk_bf16_f32 v23, v62, v63
    buffer_store_dwordx4 v[20:23], v232, s[44:47], s101 offen offset:256 sc1
    v_cvt_pk_bf16_f32 v24, v64, v65
    v_cvt_pk_bf16_f32 v25, v66, v67
    v_cvt_pk_bf16_f32 v26, v68, v69
    v_cvt_pk_bf16_f32 v27, v70, v71
    buffer_store_dwordx4 v[24:27], v232, s[44:47], s101 offen offset:2048 sc1
    v_cvt_pk_bf16_f32 v28, v72, v73
    v_cvt_pk_bf16_f32 v29, v74, v75
    v_cvt_pk_bf16_f32 v30, v76, v77
    v_cvt_pk_bf16_f32 v31, v78, v79
    buffer_store_dwordx4 v[28:31], v232, s[44:47], s101 offen offset:2304 sc1
    v_pk_fma_f32 v[144:145], v[98:99], v[180:181], v[144:145] op_sel_hi:[0,1,1]
    v_pk_fma_f32 v[144:145], v[98:99], v[180:181], v[144:145] op_sel:[1,1,0] op_sel_hi:[1,0,1] neg_lo:[0,1,0]
    v_pk_fma_f32 v[146:147], v[144:145], v[180:181], v[146:147] op_sel_hi:[0,1,1]
    v_pk_fma_f32 v[146:147], v[144:145], v[180:181], v[146:147] op_sel:[1,1,0] op_sel_hi:[1,0,1] neg_lo:[0,1,0]
    v_pk_fma_f32 v[148:149], v[146:147], v[180:181], v[148:149] op_sel_hi:[0,1,1]
    v_pk_fma_f32 v[148:149], v[146:147], v[180:181], v[148:149] op_sel:[1,1,0] op_sel_hi:[1,0,1] neg_lo:[0,1,0]
    v_pk_fma_f32 v[150:151], v[148:149], v[180:181], v[150:151] op_sel_hi:[0,1,1]
    v_pk_fma_f32 v[150:151], v[148:149], v[180:181], v[150:151] op_sel:[1,1,0] op_sel_hi:[1,0,1] neg_lo:[0,1,0]
    v_pk_fma_f32 v[152:153], v[150:151], v[180:181], v[152:153] op_sel_hi:[0,1,1]
    v_pk_fma_f32 v[152:153], v[150:151], v[180:181], v[152:153] op_sel:[1,1,0] op_sel_hi:[1,0,1] neg_lo:[0,1,0]
    v_pk_fma_f32 v[154:155], v[152:153], v[180:181], v[154:155] op_sel_hi:[0,1,1]
    v_pk_fma_f32 v[154:155], v[152:153], v[180:181], v[154:155] op_sel:[1,1,0] op_sel_hi:[1,0,1] neg_lo:[0,1,0]
    v_pk_fma_f32 v[156:157], v[154:155], v[180:181], v[156:157] op_sel_hi:[0,1,1]
    v_pk_fma_f32 v[156:157], v[154:155], v[180:181], v[156:157] op_sel:[1,1,0] op_sel_hi:[1,0,1] neg_lo:[0,1,0]
    v_pk_fma_f32 v[158:159], v[156:157], v[180:181], v[158:159] op_sel_hi:[0,1,1]
    v_pk_fma_f32 v[158:159], v[156:157], v[180:181], v[158:159] op_sel:[1,1,0] op_sel_hi:[1,0,1] neg_lo:[0,1,0]
    v_pk_fma_f32 v[160:161], v[100:101], v[182:183], v[160:161] op_sel_hi:[0,1,1]
    v_pk_fma_f32 v[160:161], v[100:101], v[182:183], v[160:161] op_sel:[1,1,0] op_sel_hi:[1,0,1] neg_lo:[0,1,0]
    v_pk_fma_f32 v[162:163], v[160:161], v[182:183], v[162:163] op_sel_hi:[0,1,1]
    v_pk_fma_f32 v[162:163], v[160:161], v[182:183], v[162:163] op_sel:[1,1,0] op_sel_hi:[1,0,1] neg_lo:[0,1,0]
    v_pk_fma_f32 v[164:165], v[162:163], v[182:183], v[164:165] op_sel_hi:[0,1,1]
    v_pk_fma_f32 v[164:165], v[162:163], v[182:183], v[164:165] op_sel:[1,1,0] op_sel_hi:[1,0,1] neg_lo:[0,1,0]
    v_pk_fma_f32 v[166:167], v[164:165], v[182:183], v[166:167] op_sel_hi:[0,1,1]
    v_pk_fma_f32 v[166:167], v[164:165], v[182:183], v[166:167] op_sel:[1,1,0] op_sel_hi:[1,0,1] neg_lo:[0,1,0]
    v_pk_fma_f32 v[168:169], v[166:167], v[182:183], v[168:169] op_sel_hi:[0,1,1]
    v_pk_fma_f32 v[168:169], v[166:167], v[182:183], v[168:169] op_sel:[1,1,0] op_sel_hi:[1,0,1] neg_lo:[0,1,0]
    v_pk_fma_f32 v[170:171], v[168:169], v[182:183], v[170:171] op_sel_hi:[0,1,1]
    v_pk_fma_f32 v[170:171], v[168:169], v[182:183], v[170:171] op_sel:[1,1,0] op_sel_hi:[1,0,1] neg_lo:[0,1,0]
    v_pk_fma_f32 v[172:173], v[170:171], v[182:183], v[172:173] op_sel_hi:[0,1,1]
    v_pk_fma_f32 v[172:173], v[170:171], v[182:183], v[172:173] op_sel:[1,1,0] op_sel_hi:[1,0,1] neg_lo:[0,1,0]
    v_pk_fma_f32 v[174:175], v[172:173], v[182:183], v[174:175] op_sel_hi:[0,1,1]
    v_pk_fma_f32 v[174:175], v[172:173], v[182:183], v[174:175] op_sel:[1,1,0] op_sel_hi:[1,0,1] neg_lo:[0,1,0]
    v_cvt_pk_bf16_f32 v32, v144, v146
    v_cvt_pk_bf16_f32 v33, v148, v150
    v_cvt_pk_bf16_f32 v34, v152, v154
    v_cvt_pk_bf16_f32 v35, v156, v158
    v_cvt_pk_bf16_f32 v36, v160, v162
    v_cvt_pk_bf16_f32 v37, v164, v166
    v_mfma_f32_16x16x32_bf16 v[112:115], v[32:35], v[104:107], 0
    v_cvt_pk_bf16_f32 v38, v168, v170
    v_cvt_pk_bf16_f32 v39, v172, v174
    v_mfma_f32_16x16x32_bf16 v[120:123], v[32:35], v[108:111], 0
    v_cvt_pk_bf16_f32 v40, v145, v147
    v_cvt_pk_bf16_f32 v41, v149, v151
    v_mfma_f32_16x16x32_bf16 v[116:119], v[36:39], v[104:107], 0
    v_cvt_pk_bf16_f32 v42, v153, v155
    v_cvt_pk_bf16_f32 v43, v157, v159
    v_mfma_f32_16x16x32_bf16 v[124:127], v[36:39], v[108:111], 0
    v_cvt_pk_bf16_f32 v44, v161, v163
    v_cvt_pk_bf16_f32 v45, v165, v167
    v_mfma_f32_16x16x32_bf16 v[128:131], v[40:43], v[104:107], 0
    v_cvt_pk_bf16_f32 v46, v169, v171
    v_cvt_pk_bf16_f32 v47, v173, v175
    v_mfma_f32_16x16x32_bf16 v[136:139], v[40:43], v[108:111], 0
    s_nop 0
    v_mfma_f32_16x16x32_bf16 v[132:135], v[44:47], v[104:107], 0
    v_mfma_f32_16x16x32_bf16 v[140:143], v[44:47], v[108:111], 0
    v_cvt_pk_bf16_f32 v32, v112, v113
    v_cvt_pk_bf16_f32 v33, v114, v115
    v_cvt_pk_bf16_f32 v34, v116, v117
    v_cvt_pk_bf16_f32 v35, v118, v119
    s_add_u32 s101, s101, 4096
    buffer_store_dwordx4 v[32:35], v232, s[44:47], s101 offen offset:0 sc1
    v_cvt_pk_bf16_f32 v36, v120, v121
    v_cvt_pk_bf16_f32 v37, v122, v123
    v_cvt_pk_bf16_f32 v38, v124, v125
    v_cvt_pk_bf16_f32 v39, v126, v127
    buffer_store_dwordx4 v[36:39], v232, s[44:47], s101 offen offset:256 sc1
    v_cvt_pk_bf16_f32 v40, v128, v129
    v_cvt_pk_bf16_f32 v41, v130, v131
    v_cvt_pk_bf16_f32 v42, v132, v133
    v_cvt_pk_bf16_f32 v43, v134, v135
    buffer_store_dwordx4 v[40:43], v232, s[44:47], s101 offen offset:2048 sc1
    v_cvt_pk_bf16_f32 v44, v136, v137
    v_cvt_pk_bf16_f32 v45, v138, v139
    v_cvt_pk_bf16_f32 v46, v140, v141
    v_cvt_pk_bf16_f32 v47, v142, v143
    buffer_store_dwordx4 v[44:47], v232, s[44:47], s101 offen offset:2304 sc1
    s_mov_b32 s77, 0
    s_cmp_eq_u32 s62, 0
    s_cbranch_scc0 L_nogate
    s_lshl_b32 s72, s63, 7
    s_add_u32 s72, s72, 151552
    v_and_b32 v4, 48, v0
    v_add_u32 v252, s72, v4
    ds_read_b128 v[80:83], v252 offset:0
    ds_read_b128 v[84:87], v252 offset:64
    ds_read_b128 v[88:91], v252 offset:128
    ds_read_b128 v[92:95], v252 offset:192
    ds_read_b128 v[96:99], v252 offset:256
    ds_read_b128 v[100:103], v252 offset:320
    ds_read_b128 v[104:107], v252 offset:384
    ds_read_b128 v[108:111], v252 offset:448
    s_waitcnt lgkmcnt(7)
    v_mfma_f32_16x16x32_bf16 v[56:59], v[80:83], a[0:3], 0
    v_mfma_f32_16x16x32_bf16 v[60:63], v[80:83], a[4:7], 0
    ds_read_b128 v[80:83], v252 offset:512
    s_waitcnt lgkmcnt(7)
    v_mfma_f32_16x16x32_bf16 v[56:59], v[84:87], a[8:11], v[56:59]
    v_mfma_f32_16x16x32_bf16 v[60:63], v[84:87], a[12:15], v[60:63]
    ds_read_b128 v[84:87], v252 offset:576
    s_waitcnt lgkmcnt(7)
    v_mfma_f32_16x16x32_bf16 v[56:59], v[88:91], a[16:19], v[56:59]
    v_mfma_f32_16x16x32_bf16 v[60:63], v[88:91], a[20:23], v[60:63]
    ds_read_b128 v[88:91], v252 offset:640
    s_waitcnt lgkmcnt(7)
    v_mfma_f32_16x16x32_bf16 v[56:59], v[92:95], a[24:27], v[56:59]
    v_mfma_f32_16x16x32_bf16 v[60:63], v[92:95], a[28:31], v[60:63]
    ds_read_b128 v[92:95], v252 offset:704
    s_waitcnt lgkmcnt(7)
    v_mfma_f32_16x16x32_bf16 v[56:59], v[96:99], a[32:35], v[56:59]
    v_mfma_f32_16x16x32_bf16 v[60:63], v[96:99], a[36:39], v[60:63]
    ds_read_b128 v[96:99], v252 offset:768
    s_waitcnt lgkmcnt(7)
    v_mfma_f32_16x16x32_bf16 v[56:59], v[100:103], a[40:43], v[56:59]
    v_mfma_f32_16x16x32_bf16 v[60:63], v[100:103], a[44:47], v[60:63]
    ds_read_b128 v[100:103], v252 offset:832
    s_waitcnt lgkmcnt(7)
    v_mfma_f32_16x16x32_bf16 v[56:59], v[104:107], a[48:51], v[56:59]
    v_mfma_f32_16x16x32_bf16 v[60:63], v[104:107], a[52:55], v[60:63]
    ds_read_b128 v[104:107], v252 offset:896
    s_waitcnt lgkmcnt(7)
    v_mfma_f32_16x16x32_bf16 v[56:59], v[108:111], a[56:59], v[56:59]
    v_mfma_f32_16x16x32_bf16 v[60:63], v[108:111], a[60:63], v[60:63]
    ds_read_b128 v[108:111], v252 offset:960
    s_waitcnt lgkmcnt(7)
    v_mfma_f32_16x16x32_bf16 v[56:59], v[80:83], a[64:67], v[56:59]
    v_mfma_f32_16x16x32_bf16 v[60:63], v[80:83], a[68:71], v[60:63]
    s_waitcnt lgkmcnt(6)
    v_mfma_f32_16x16x32_bf16 v[56:59], v[84:87], a[72:75], v[56:59]
    v_mfma_f32_16x16x32_bf16 v[60:63], v[84:87], a[76:79], v[60:63]
    s_waitcnt lgkmcnt(5)
    v_mfma_f32_16x16x32_bf16 v[56:59], v[88:91], a[80:83], v[56:59]
    v_mfma_f32_16x16x32_bf16 v[60:63], v[88:91], a[84:87], v[60:63]
    s_waitcnt lgkmcnt(4)
    v_mfma_f32_16x16x32_bf16 v[56:59], v[92:95], a[88:91], v[56:59]
    v_mfma_f32_16x16x32_bf16 v[60:63], v[92:95], a[92:95], v[60:63]
    s_waitcnt lgkmcnt(3)
    v_mfma_f32_16x16x32_bf16 v[56:59], v[96:99], a[96:99], v[56:59]
    v_mfma_f32_16x16x32_bf16 v[60:63], v[96:99], a[100:103], v[60:63]
    s_waitcnt lgkmcnt(2)
    v_mfma_f32_16x16x32_bf16 v[56:59], v[100:103], a[104:107], v[56:59]
    v_mfma_f32_16x16x32_bf16 v[60:63], v[100:103], a[108:111], v[60:63]
    s_waitcnt lgkmcnt(1)
    v_mfma_f32_16x16x32_bf16 v[56:59], v[104:107], a[112:115], v[56:59]
    v_mfma_f32_16x16x32_bf16 v[60:63], v[104:107], a[116:119], v[60:63]
    s_waitcnt lgkmcnt(0)
    v_mfma_f32_16x16x32_bf16 v[56:59], v[108:111], a[120:123], v[56:59]
    v_mfma_f32_16x16x32_bf16 v[60:63], v[108:111], a[124:127], v[60:63]
    v_bfe_u32 v4, v0, 4, 1
    v_bfe_u32 v5, v0, 2, 2
    v_and_b32 v6, 12, v14
    v_lshl_add_u32 v6, v5, 5, v6
    v_lshl_add_u32 v6, v4, 4, v6
    s_lshl_b32 s72, s79, 7
    s_add_u32 s72, s72, 81920
    s_lshl_b32 s74, s79, 11
    s_add_u32 s74, s74, 918032
    s_mov_b32 s77, 3
    s_mov_b32 exec_lo, 0xffff0000
    s_mov_b32 exec_hi, 0xffff0000
    v_mov_b32 v56, v60
    s_mov_b64 exec, -1
    v_mul_f32 v4, 0xbfb8aa3b, v56
    v_exp_f32 v4, v4
    s_nop 0
    v_add_f32 v4, 1.0, v4
    v_rcp_f32 v4, v4
    s_nop 0
    buffer_store_dword v4, v6, s[44:47], s72 offen sc1
    s_branch L_gated
L_nogate:
    buffer_load_dword v15, v1, s[36:39], s35 offen
L_gated:
    ds_read_b64_tr_b16 a[192:193], v234 offset:0
    ds_read_b64_tr_b16 a[194:195], v234 offset:1024
    ds_read_b64_tr_b16 a[196:197], v235 offset:0
    ds_read_b64_tr_b16 a[198:199], v235 offset:1024
    ds_read_b64_tr_b16 a[200:201], v234 offset:2048
    ds_read_b64_tr_b16 a[202:203], v234 offset:3072
    ds_read_b64_tr_b16 a[204:205], v235 offset:2048
    ds_read_b64_tr_b16 a[206:207], v235 offset:3072
    ds_read_b64_tr_b16 a[208:209], v234 offset:4096
    ds_read_b64_tr_b16 a[210:211], v234 offset:5120
    ds_read_b64_tr_b16 a[212:213], v235 offset:4096
    ds_read_b64_tr_b16 a[214:215], v235 offset:5120
    ds_read_b64_tr_b16 a[216:217], v234 offset:6144
    ds_read_b64_tr_b16 a[218:219], v234 offset:7168
    ds_read_b64_tr_b16 a[220:221], v235 offset:6144
    ds_read_b64_tr_b16 a[222:223], v235 offset:7168
    ds_read_b64_tr_b16 a[224:225], v234 offset:8192
    ds_read_b64_tr_b16 a[226:227], v234 offset:9216
    ds_read_b64_tr_b16 a[228:229], v235 offset:8192
    ds_read_b64_tr_b16 a[230:231], v235 offset:9216
    ds_read_b64_tr_b16 a[232:233], v234 offset:10240
    ds_read_b64_tr_b16 a[234:235], v234 offset:11264
    ds_read_b64_tr_b16 a[236:237], v235 offset:10240
    ds_read_b64_tr_b16 a[238:239], v235 offset:11264
    ds_read_b64_tr_b16 a[240:241], v234 offset:12288
    ds_read_b64_tr_b16 a[242:243], v234 offset:13312
    ds_read_b64_tr_b16 a[244:245], v235 offset:12288
    ds_read_b64_tr_b16 a[246:247], v235 offset:13312
    ds_read_b64_tr_b16 a[248:249], v234 offset:14336
    ds_read_b64_tr_b16 a[250:251], v234 offset:15360
    ds_read_b64_tr_b16 a[252:253], v235 offset:14336
    ds_read_b64_tr_b16 a[254:255], v235 offset:15360
    s_mov_b32 m0, s24
    s_nop 0
    buffer_load_dwordx4 v216, s[36:39], s35 offen lds
    buffer_load_dwordx4 v217, s[36:39], s35 offen offset:1024 lds
    s_waitcnt lgkmcnt(0)
    s_barrier
    s_add_u32 s2, s2, 32768
    s_add_u32 m0, s81, 4096
    s_nop 0
    buffer_load_dwordx4 v216, s[48:51], s2 offen lds
    buffer_load_dwordx4 v217, s[48:51], s2 offen offset:1024 lds
    buffer_load_dwordx4 v218, s[48:51], s2 offen offset:2048 lds
    buffer_load_dwordx4 v219, s[48:51], s2 offen offset:3072 lds
    s_xor_b32 s2, s33, 768
    s_add_u32 m0, s81, 98304
    s_nop 0
    buffer_load_dwordx4 v216, s[48:51], s2 offen lds
    buffer_load_dwordx4 v217, s[48:51], s2 offen offset:1024 lds
    buffer_load_dwordx4 v218, s[48:51], s2 offen offset:2048 lds
    buffer_load_dwordx4 v219, s[48:51], s2 offen offset:3072 lds
    s_waitcnt vmcnt(11)
    s_atomic_swap s66, s[44:45], s86
    s_add_u32 s2, s2, 32768
    s_add_u32 m0, s81, 102400
    s_nop 0
    buffer_load_dwordx4 v216, s[48:51], s2 offen lds
    buffer_load_dwordx4 v217, s[48:51], s2 offen offset:1024 lds
    buffer_load_dwordx4 v218, s[48:51], s2 offen offset:2048 lds
    buffer_load_dwordx4 v219, s[48:51], s2 offen offset:3072 lds
    s_xor_b32 s2, s33, 256
    s_add_u32 m0, s81, 32768
    s_nop 0
    buffer_load_dwordx4 v218, s[48:51], s2 offen offset:2048 lds
    buffer_load_dwordx4 v219, s[48:51], s2 offen offset:3072 lds
    s_add_u32 s2, s2, 32768
    s_add_u32 m0, s81, 36864
    s_nop 0
    buffer_load_dwordx4 v216, s[48:51], s2 offen lds
    buffer_load_dwordx4 v217, s[48:51], s2 offen offset:1024 lds
    buffer_load_dwordx4 v218, s[48:51], s2 offen offset:2048 lds
    buffer_load_dwordx4 v219, s[48:51], s2 offen offset:3072 lds
    s_xor_b32 s2, s33, 512
    s_add_u32 m0, s81, 65536
    s_nop 0
    buffer_load_dwordx4 v216, s[48:51], s2 offen lds
    buffer_load_dwordx4 v217, s[48:51], s2 offen offset:1024 lds
    buffer_load_dwordx4 v218, s[48:51], s2 offen offset:2048 lds
    buffer_load_dwordx4 v219, s[48:51], s2 offen offset:3072 lds
    s_add_u32 s2, s2, 32768
    s_add_u32 m0, s81, 69632
    s_nop 0
    buffer_load_dwordx4 v216, s[48:51], s2 offen lds
    buffer_load_dwordx4 v217, s[48:51], s2 offen offset:1024 lds
    buffer_load_dwordx4 v218, s[48:51], s2 offen offset:2048 lds
    buffer_load_dwordx4 v219, s[48:51], s2 offen offset:3072 lds
    s_load_dwordx4 s[8:11], s[44:45], s5 glc
    s_branch L_phase2
.p2align 3
.fill 538, 4, 0xbf800000
L_attn:
    s_mov_b64 exec, 1
    global_load_dword v2, v1, s[34:35] sc1
    s_mov_b64 exec, -1
    v_and_b32 v4, 3, v0
    v_bfe_u32 v5, v0, 2, 2
    v_lshlrev_b32 v6, 7, v5
    v_lshl_add_u32 v6, v4, 10, v6
    v_mul_u32_u24 v4, 3072, v4
    v_mul_u32_u24 v5, 196608, v5
    v_add_u32 v4, v4, v5
    s_and_b32 s72, s62, 6
    s_add_u32 s72, s72, s67
    s_lshl_b32 s72, s72, 12
    s_add_u32 s72, s72, s68
    s_lshr_b32 s73, s61, 1
    s_mul_i32 s73, s73, 12288
    s_add_u32 s73, s73, s69
    s_add_u32 s73, s73, 196608
    v_add_u32 v175, s73, v4
    v_add_u32 v174, s72, v6
    v_and_b32 v4, 15, v0
    v_lshrrev_b32 v5, 4, v0
    v_lshrrev_b32 v6, 1, v4
    v_xor_b32 v6, v6, v5
    v_lshlrev_b32 v6, 4, v6
    v_lshl_add_u32 v6, v4, 7, v6
    s_and_b32 s72, s76, 8192
    v_add_u32 v229, s72, v6
    v_xor_b32 v230, 64, v229
    v_and_b32 v6, 0x1ff, v234
    v_lshl_add_u32 v231, v5, 10, v6
    buffer_load_dwordx4 v210, s[36:39], s68 offen offset:2048 lds
    v_xor_b32 v252, 32, v231
    s_lshr_b32 s101, s62, 2
    s_lshl1_add_u32 s29, s79, s101
    s_lshl_b32 s29, s29, 8
    s_and_b32 s101, s62, 3
    s_add_u32 s29, s29, s101
    s_lshl2_add_u32 s29, s29, 918016
    s_load_dword s8, s[44:45], s29 glc
    s_lshl2_add_u32 s74, s62, s60
    s_lshl4_add_u32 s75, s74, s61
    s_lshl_b32 s84, s75, 9
    buffer_load_dwordx4 v211, s[36:39], s68 offen offset:3072 lds
    s_add_u32 s84, s84, 262144
    v_lshlrev_b32 v253, 3, v0
    v_mov_b32 v8, 0x3f80
    v_mov_b32 v9, 0
    v_and_b32 v10, 48, v13
    v_mov_b64 v[160:161], 0
    v_mov_b64 v[162:163], 0
    v_lshlrev_b64 v[8:9], v10, v[8:9]
    s_mov_b32 exec_lo, 0xf0000f
    s_mov_b32 exec_hi, 0xf0000f
    v_mov_b64 v[160:161], v[8:9]
    s_mov_b64 exec, -1
    s_add_u32 s69, s69, s70
    s_add_u32 m0, s77, 32768
    s_nop 0
    buffer_load_dwordx4 v212, s[40:43], s69 offen lds
    s_mov_b32 exec_lo, 0xf0000f00
    s_mov_b32 exec_hi, 0xf0000f00
    v_mov_b64 v[162:163], v[8:9]
    s_mov_b64 exec, -1
    s_lshl_b32 s85, s75, 6
    s_add_u32 s85, s85, 98304
    v_mov_b64 v[112:113], -1
    s_mov_b32 s82, 0x3fb8aa3b
    s_mov_b32 s83, 0x3fb8aa3b
    s_mov_b32 s86, 0x358637bd
    s_mov_b32 s87, 0x358637bd
    buffer_load_dwordx4 v213, s[40:43], s69 offen offset:1024 lds
    v_mov_b32 v254, 0xbfb8aa3b
    v_mov_b32 v255, 0xbfb8aa3b
    v_bfe_u32 v4, v0, 2, 2
    s_lshl_b32 s72, s80, 1
    v_xor_b32 v4, s72, v4
    v_mov_b32 v5, 0x3f803f80
    v_cmp_eq_u32 vcc, 0, v4
    s_nop 1
    v_cndmask_b32 v144, 0, v5, vcc
    v_mov_b32 v145, v144
    v_mov_b64 v[146:147], v[144:145]
    v_cmp_eq_u32 vcc, 1, v4
    s_nop 1
    v_cndmask_b32 v148, 0, v5, vcc
    buffer_load_dwordx4 v214, s[40:43], s69 offen offset:2048 lds
    v_mov_b32 v149, v148
    v_mov_b64 v[150:151], v[148:149]
    s_lshl_b32 s71, s74, 10
    s_add_u32 s71, s71, 851968
    s_lshl2_add_u32 s75, s61, s71
    s_load_dword s8, s[44:45], s75 glc
    s_lshr_b32 s72, s60, 1
    s_lshl3_add_u32 s72, s80, s72
    s_lshl_b32 s72, s72, 10
    s_add_u32 s72, s72, 131072
    v_add_u32 v244, s72, v13
    buffer_load_dwordx4 v215, s[40:43], s69 offen offset:3072 lds
    s_mov_b64 exec, 0xf0
    buffer_load_dword v173, v174, s[36:39], 0 offen
    buffer_load_dword v173, v175, s[40:43], 0 offen
    s_mov_b64 exec, -1
    s_add_u32 s68, s68, 128
    s_add_u32 m0, s76, 65536
    s_waitcnt vmcnt(11)
    s_barrier
    ds_read_b64_tr_b16 v[176:177], v231 offset:16384
    ds_read_b64_tr_b16 v[178:179], v231 offset:16896
    ds_read_b128 v[80:83], v229 offset:0
    ds_read_b128 v[84:87], v229 offset:2048
    ds_read_b128 v[88:91], v229 offset:4096
    ds_read_b128 v[92:95], v229 offset:6144
    ds_read_b64_tr_b16 v[180:181], v252 offset:16384
    ds_read_b64_tr_b16 v[182:183], v252 offset:16896
    buffer_load_dwordx4 v208, s[36:39], s68 offen lds
    buffer_load_dwordx4 v209, s[36:39], s68 offen offset:1024 lds
    buffer_load_dwordx4 v210, s[36:39], s68 offen offset:2048 lds
    buffer_load_dwordx4 v211, s[36:39], s68 offen offset:3072 lds
    s_add_u32 s69, s69, s70
    s_add_u32 m0, s77, 65536
    s_waitcnt lgkmcnt(2)
    v_mfma_f32_16x16x32_bf16 v[16:19], v[80:83], v[176:179], 1.0
    ds_read_b64_tr_b16 v[184:185], v231 offset:24576
    ds_read_b64_tr_b16 v[186:187], v231 offset:25088
    ds_read_b64_tr_b16 v[188:189], v252 offset:24576
    buffer_load_dwordx4 v212, s[40:43], s69 offen lds
    v_mfma_f32_16x16x32_bf16 v[20:23], v[84:87], v[176:179], 1.0
    ds_read_b64_tr_b16 v[190:191], v252 offset:25088
    v_mfma_f32_16x16x32_bf16 v[24:27], v[88:91], v[176:179], 1.0
    ds_read_b128 a[0:3], v224 offset:0
    buffer_load_dwordx4 v213, s[40:43], s69 offen offset:1024 lds
    v_mfma_f32_16x16x32_bf16 v[28:31], v[92:95], v[176:179], 1.0
    ds_read_b128 a[4:7], v225 offset:0
    s_waitcnt lgkmcnt(6)
    v_mfma_f32_16x16x32_bf16 v[44:47], v[92:95], v[180:183], 1.0
    buffer_load_dwordx4 v214, s[40:43], s69 offen offset:2048 lds
    v_mfma_f32_16x16x32_bf16 v[40:43], v[88:91], v[180:183], 1.0
    v_mfma_f32_16x16x32_bf16 v[36:39], v[84:87], v[180:183], 1.0
    buffer_load_dwordx4 v215, s[40:43], s69 offen offset:3072 lds
    v_mfma_f32_16x16x32_bf16 v[32:35], v[80:83], v[180:183], 1.0
    s_add_u32 s68, s68, 128
    s_add_u32 m0, s76, 98304
    s_mov_b64 exec, 0xf00
    buffer_load_dword v173, v174, s[36:39], 0 offen
    buffer_load_dword v173, v175, s[40:43], 0 offen
    s_mov_b64 exec, -1
    s_waitcnt lgkmcnt(4)
    v_mfma_f32_16x16x32_bf16 v[48:51], v[80:83], v[184:187], 0
    ds_read_b64_tr_b16 v[176:177], v231 offset:20480
    ds_read_b64_tr_b16 v[178:179], v231 offset:20992
    ds_read_b128 v[96:99], v230 offset:0
    v_mfma_f32_16x16x32_bf16 v[52:55], v[84:87], v[184:187], 0
    ds_read_b128 v[100:103], v230 offset:2048
    v_mfma_f32_16x16x32_bf16 v[56:59], v[88:91], v[184:187], 0
    ds_read_b128 v[104:107], v230 offset:4096
    v_mfma_f32_16x16x32_bf16 v[60:63], v[92:95], v[184:187], 0
    ds_read_b128 v[108:111], v230 offset:6144
    s_waitcnt lgkmcnt(8)
    v_mfma_f32_16x16x32_bf16 v[76:79], v[92:95], v[188:191], 0
    v_mfma_f32_16x16x32_bf16 v[72:75], v[88:91], v[188:191], 0
    ds_read_b64_tr_b16 v[180:181], v252 offset:20480
    ds_read_b64_tr_b16 v[182:183], v252 offset:20992
    v_mfma_f32_16x16x32_bf16 v[68:71], v[84:87], v[188:191], 0
    v_mfma_f32_16x16x32_bf16 v[64:67], v[80:83], v[188:191], 0
    s_waitcnt lgkmcnt(2)
    v_mfma_f32_16x16x32_bf16 v[16:19], v[96:99], v[176:179], v[16:19]
    ds_read_b64_tr_b16 v[184:185], v231 offset:28672
    ds_read_b64_tr_b16 v[186:187], v231 offset:29184
    ds_read_b64_tr_b16 v[188:189], v252 offset:28672
    v_mfma_f32_16x16x32_bf16 v[20:23], v[100:103], v[176:179], v[20:23]
    ds_read_b64_tr_b16 v[190:191], v252 offset:29184
    v_mfma_f32_16x16x32_bf16 v[24:27], v[104:107], v[176:179], v[24:27]
    ds_read_b128 a[8:11], v226 offset:0
    v_mfma_f32_16x16x32_bf16 v[28:31], v[108:111], v[176:179], v[28:31]
    ds_read_b128 a[12:15], v227 offset:0
    s_waitcnt lgkmcnt(6)
    v_mfma_f32_16x16x32_bf16 v[44:47], v[108:111], v[180:183], v[44:47]
    v_mfma_f32_16x16x32_bf16 v[40:43], v[104:107], v[180:183], v[40:43]
    v_mfma_f32_16x16x32_bf16 v[36:39], v[100:103], v[180:183], v[36:39]
    v_mfma_f32_16x16x32_bf16 v[32:35], v[96:99], v[180:183], v[32:35]
    s_add_u32 s72, s76, 131072
    v_add_u32 v245, s72, v13
    s_lshl_b32 s72, s60, 8
    s_add_u32 s72, s72, 147456
    v_add_u32 v246, s72, v14
    s_lshl_b32 s72, s60, 6
    s_add_u32 s72, s72, 147456
    v_and_b32 v248, 60, v14
    v_add_u32 v247, s72, v248
    v_add_u32 v250, 131072, v234
    v_add_u32 v251, 131072, v235
    v_add_u32 v248, 0x18000, v234
    v_add_u32 v249, 0x18000, v235
    s_lshr_b32 s72, s60, 1
    s_lshl_b32 s72, s72, 10
    s_lshl_b32 s73, s80, 8
    s_add_u32 s73, s73, s72
    s_add_u32 s73, s73, 151552
    v_and_b32 v8, 7, v0
    v_lshrrev_b32 v9, 5, v0
    v_lshl_add_u32 v8, v8, 1, v9
    v_lshlrev_b32 v8, 4, v8
    v_bfe_u32 v9, v0, 3, 1
    v_bfe_u32 v10, v0, 4, 1
    v_lshl_add_u32 v8, v9, 9, v8
    v_lshl_add_u32 v8, v10, 3, v8
    v_add_u32 v168, s73, v8
    s_lshl_b32 s73, s80, 5
    s_add_u32 s73, s73, s72
    s_add_u32 s73, s73, 153600
    v_bfe_u32 v8, v0, 2, 1
    v_bfe_u32 v9, v0, 3, 1
    v_and_b32 v10, 3, v0
    v_lshl_add_u32 v10, v10, 1, s73
    v_lshl_add_u32 v10, v9, 3, v10
    v_lshl_add_u32 v169, v8, 4, v10
    v_add_u32 v170, 151552, v13
    v_mov_b32 v171, v170
    v_lshrrev_b32 v9, 5, v0
    v_lshlrev_b32 v9, 4, v9
    s_mov_b32 exec_lo, 0xffff0000
    s_mov_b32 exec_hi, 0xffff0000
    v_add_u32 v170, 153600, v9
    s_mov_b64 exec, -1
    s_mov_b32 exec_lo, 0xffff
    s_mov_b32 exec_hi, 0xffff
    v_add_u32 v171, 153632, v9
    s_mov_b64 exec, -1
    v_bfe_u32 v9, v0, 3, 2
    v_and_b32 v10, 35, v0
    v_lshl_add_u32 v10, v9, 2, v10
    v_lshl_add_u32 v10, v8, 4, v10
    v_lshlrev_b32 v172, 4, v10
    s_mul_i32 s28, s79, 98304
    s_lshl_b32 s73, s62, 12
    s_add_u32 s28, s28, s73
    s_add_u32 s28, s28, 1114112
    s_and_b32 s30, s61, 1
    s_lshl1_add_u32 s30, s74, s30
    s_lshl_b32 s30, s30, 12
    s_add_u32 s30, s30, 262144
    s_lshl_b32 s31, s74, 10
    s_add_u32 s31, s31, 98304
    s_lshr_b32 s4, s60, 1
    s_lshl1_add_u32 s4, s64, s4
    s_lshl1_add_u32 s5, s4, s80
    s_lshl_b32 s5, s5, 10
    s_add_u32 s5, s5, 917504
    s_mul_i32 s34, s4, 3
    s_add_u32 s34, s34, s80
    s_and_b32 s35, s65, 3
    s_lshl2_add_u32 s34, s34, s35
    s_lshl_b32 s34, s34, 13
    s_add_u32 s34, s34, 1048576
    s_lshl2_add_u32 s35, s64, s60
    s_lshl_b32 s35, s35, 7
    s_add_u32 s35, s35, s65
    s_lshl_b32 s35, s35, 7
    s_lshr_b32 s24, s76, 1
    s_add_u32 s24, s24, 155648
    s_lshl1_add_u32 s25, s65, s80
    s_lshl_b32 s25, s25, 6
    buffer_store_dwordx2 v[112:113], v253, s[44:47], s84 offen sc1
    s_mov_b64 exec, 0xffff
    buffer_store_dword v112, v14, s[44:47], s85 offen sc1
    s_mov_b64 exec, -1
    s_waitcnt vmcnt(14)
    s_barrier
    s_waitcnt lgkmcnt(4)
    v_mfma_f32_16x16x32_bf16 v[48:51], v[96:99], v[184:187], v[48:51]
    ds_read_b64_tr_b16 v[176:177], v231 offset:49152
    ds_read_b64_tr_b16 v[178:179], v231 offset:49664
    ds_read_b128 v[80:83], v229 offset:32768
    v_mfma_f32_16x16x32_bf16 v[52:55], v[100:103], v[184:187], v[52:55]
    ds_read_b128 v[84:87], v229 offset:34816
    v_readfirstlane_b32 s66, v2
    v_mfma_f32_16x16x32_bf16 v[56:59], v[104:107], v[184:187], v[56:59]
    ds_read_b128 v[88:91], v229 offset:36864
    s_mul_i32 s66, s66, 0x9E3779B5
    v_mfma_f32_16x16x32_bf16 v[60:63], v[108:111], v[184:187], v[60:63]
    ds_read_b128 v[92:95], v229 offset:38912
    s_waitcnt lgkmcnt(8)
    v_mfma_f32_16x16x32_bf16 v[76:79], v[108:111], v[188:191], v[76:79]
    buffer_load_dwordx4 v208, s[36:39], s68 offen lds
    v_mfma_f32_16x16x32_bf16 v[72:75], v[104:107], v[188:191], v[72:75]
    ds_read_b64_tr_b16 v[180:181], v252 offset:49152
    ds_read_b64_tr_b16 v[182:183], v252 offset:49664
    v_mfma_f32_16x16x32_bf16 v[68:71], v[100:103], v[188:191], v[68:71]
    buffer_load_dwordx4 v209, s[36:39], s68 offen offset:1024 lds
    v_mfma_f32_16x16x32_bf16 v[64:67], v[96:99], v[188:191], v[64:67]
    v_xor_b32 v229, 0x10000, v229
    s_waitcnt lgkmcnt(2)
    v_mfma_f32_16x16x32_bf16 v[16:19], v[80:83], v[176:179], v[16:19]
    ds_read_b64_tr_b16 v[184:185], v231 offset:57344
    ds_read_b64_tr_b16 v[186:187], v231 offset:57856
    ds_read_b64_tr_b16 v[188:189], v252 offset:57344
    v_mfma_f32_16x16x32_bf16 v[20:23], v[84:87], v[176:179], v[20:23]
    ds_read_b64_tr_b16 v[190:191], v252 offset:57856
    s_add_u32 s66, s66, 0x7F4A7C15
    v_mfma_f32_16x16x32_bf16 v[24:27], v[88:91], v[176:179], v[24:27]
    ds_read_b128 a[16:19], v224 offset:32768
    v_mov_b32 v12, s66
    v_mfma_f32_16x16x32_bf16 v[28:31], v[92:95], v[176:179], v[28:31]
    ds_read_b128 a[20:23], v225 offset:32768
    s_waitcnt lgkmcnt(6)
    v_mfma_f32_16x16x32_bf16 v[44:47], v[92:95], v[180:183], v[44:47]
    buffer_load_dwordx4 v210, s[36:39], s68 offen offset:2048 lds
    v_mfma_f32_16x16x32_bf16 v[40:43], v[88:91], v[180:183], v[40:43]
    v_xor_b32 v224, 0x10000, v224
    v_xor_b32 v225, 0x10000, v225
    v_mfma_f32_16x16x32_bf16 v[36:39], v[84:87], v[180:183], v[36:39]
    buffer_load_dwordx4 v211, s[36:39], s68 offen offset:3072 lds
    v_mfma_f32_16x16x32_bf16 v[32:35], v[80:83], v[180:183], v[32:35]
    s_add_u32 s69, s69, s70
    s_add_u32 m0, s77, 98304
    s_waitcnt lgkmcnt(4)
    v_mfma_f32_16x16x32_bf16 v[48:51], v[80:83], v[184:187], v[48:51]
    ds_read_b64_tr_b16 v[176:177], v231 offset:53248
    ds_read_b64_tr_b16 v[178:179], v231 offset:53760
    ds_read_b128 v[96:99], v230 offset:32768
    v_mfma_f32_16x16x32_bf16 v[52:55], v[84:87], v[184:187], v[52:55]
    ds_read_b128 v[100:103], v230 offset:34816
    v_and_b32 v2, 31, v0
    v_mfma_f32_16x16x32_bf16 v[56:59], v[88:91], v[184:187], v[56:59]
    ds_read_b128 v[104:107], v230 offset:36864
    v_lshl_add_u32 v2, v2, 1, s25
    v_mfma_f32_16x16x32_bf16 v[60:63], v[92:95], v[184:187], v[60:63]
    ds_read_b128 v[108:111], v230 offset:38912
    s_waitcnt lgkmcnt(8)
    v_mfma_f32_16x16x32_bf16 v[76:79], v[92:95], v[188:191], v[76:79]
    buffer_load_dwordx4 v212, s[40:43], s69 offen lds
    v_mfma_f32_16x16x32_bf16 v[72:75], v[88:91], v[188:191], v[72:75]
    ds_read_b64_tr_b16 v[180:181], v252 offset:53248
    ds_read_b64_tr_b16 v[182:183], v252 offset:53760
    v_mfma_f32_16x16x32_bf16 v[68:71], v[84:87], v[188:191], v[68:71]
    buffer_load_dwordx4 v213, s[40:43], s69 offen offset:1024 lds
    v_mfma_f32_16x16x32_bf16 v[64:67], v[80:83], v[188:191], v[64:67]
    v_xor_b32 v230, 0x10000, v230
    s_waitcnt lgkmcnt(2)
    v_mfma_f32_16x16x32_bf16 v[16:19], v[96:99], v[176:179], v[16:19]
    ds_read_b64_tr_b16 v[184:185], v231 offset:61440
    ds_read_b64_tr_b16 v[186:187], v231 offset:61952
    ds_read_b64_tr_b16 v[188:189], v252 offset:61440
    v_mfma_f32_16x16x32_bf16 v[20:23], v[100:103], v[176:179], v[20:23]
    ds_read_b64_tr_b16 v[190:191], v252 offset:61952
    global_load_ushort v2, v2, s[20:21]
    v_mfma_f32_16x16x32_bf16 v[24:27], v[104:107], v[176:179], v[24:27]
    ds_read_b128 a[24:27], v226 offset:32768
    v_mfma_f32_16x16x32_bf16 v[28:31], v[108:111], v[176:179], v[28:31]
    ds_read_b128 a[28:31], v227 offset:32768
    s_waitcnt lgkmcnt(6)
    v_mfma_f32_16x16x32_bf16 v[44:47], v[108:111], v[180:183], v[44:47]
    buffer_load_dwordx4 v214, s[40:43], s69 offen offset:2048 lds
    v_mfma_f32_16x16x32_bf16 v[40:43], v[104:107], v[180:183], v[40:43]
    v_xor_b32 v226, 0x10000, v226
    v_xor_b32 v227, 0x10000, v227
    v_mfma_f32_16x16x32_bf16 v[36:39], v[100:103], v[180:183], v[36:39]
    buffer_load_dwordx4 v215, s[40:43], s69 offen offset:3072 lds
    v_mfma_f32_16x16x32_bf16 v[32:35], v[96:99], v[180:183], v[32:35]
    v_xor_b32 v231, 0x10000, v231
    v_xor_b32 v252, 0x10000, v252
    s_cmp_eq_u32 s63, 4
    s_cselect_b32 s2, -7, 1
    s_mul_i32 s3, s2, s70
    s_lshl_b32 s2, s2, 7
    s_add_u32 s68, s68, s2
    s_add_u32 m0, s76, 0
    s_waitcnt vmcnt(13)
    s_barrier
    s_waitcnt lgkmcnt(4)
    v_mfma_f32_16x16x32_bf16 v[48:51], v[96:99], v[184:187], v[48:51]
    ds_read_b64_tr_b16 v[176:177], v231 offset:16384
    ds_read_b64_tr_b16 v[178:179], v231 offset:16896
    ds_read_b128 v[80:83], v229 offset:0
    v_mfma_f32_16x16x32_bf16 v[52:55], v[100:103], v[184:187], v[52:55]
    ds_read_b128 v[84:87], v229 offset:2048
    v_mfma_f32_16x16x32_bf16 v[56:59], v[104:107], v[184:187], v[56:59]
    ds_read_b128 v[88:91], v229 offset:4096
    v_mfma_f32_16x16x32_bf16 v[60:63], v[108:111], v[184:187], v[60:63]
    ds_read_b128 v[92:95], v229 offset:6144
    s_waitcnt lgkmcnt(8)
    v_mfma_f32_16x16x32_bf16 v[76:79], v[108:111], v[188:191], v[76:79]
    buffer_load_dwordx4 v208, s[36:39], s68 offen lds
    v_mfma_f32_16x16x32_bf16 v[72:75], v[104:107], v[188:191], v[72:75]
    ds_read_b64_tr_b16 v[180:181], v252 offset:16384
    ds_read_b64_tr_b16 v[182:183], v252 offset:16896
    v_mfma_f32_16x16x32_bf16 v[68:71], v[100:103], v[188:191], v[68:71]
    buffer_load_dwordx4 v209, s[36:39], s68 offen offset:1024 lds
    v_mfma_f32_16x16x32_bf16 v[64:67], v[96:99], v[188:191], v[64:67]
    s_waitcnt lgkmcnt(2)
    v_mfma_f32_16x16x32_bf16 v[16:19], v[80:83], v[176:179], v[16:19]
    ds_read_b64_tr_b16 v[184:185], v231 offset:24576
    ds_read_b64_tr_b16 v[186:187], v231 offset:25088
    ds_read_b64_tr_b16 v[188:189], v252 offset:24576
    v_mfma_f32_16x16x32_bf16 v[20:23], v[84:87], v[176:179], v[20:23]
    ds_read_b64_tr_b16 v[190:191], v252 offset:25088
    v_mfma_f32_16x16x32_bf16 v[24:27], v[88:91], v[176:179], v[24:27]
    ds_read_b128 a[32:35], v224 offset:0
    v_mfma_f32_16x16x32_bf16 v[28:31], v[92:95], v[176:179], v[28:31]
    ds_read_b128 a[36:39], v225 offset:0
    s_waitcnt lgkmcnt(6)
    v_mfma_f32_16x16x32_bf16 v[44:47], v[92:95], v[180:183], v[44:47]
    buffer_load_dwordx4 v210, s[36:39], s68 offen offset:2048 lds
    v_mfma_f32_16x16x32_bf16 v[40:43], v[88:91], v[180:183], v[40:43]
    v_mfma_f32_16x16x32_bf16 v[36:39], v[84:87], v[180:183], v[36:39]
    buffer_load_dwordx4 v211, s[36:39], s68 offen offset:3072 lds
    v_mfma_f32_16x16x32_bf16 v[32:35], v[80:83], v[180:183], v[32:35]
    s_add_u32 s69, s69, s3
    s_add_u32 m0, s77, 0
    s_waitcnt lgkmcnt(4)
    v_mfma_f32_16x16x32_bf16 v[48:51], v[80:83], v[184:187], v[48:51]
    ds_read_b64_tr_b16 v[176:177], v231 offset:20480
    ds_read_b64_tr_b16 v[178:179], v231 offset:20992
    ds_read_b128 v[96:99], v230 offset:0
    v_mfma_f32_16x16x32_bf16 v[52:55], v[84:87], v[184:187], v[52:55]
    ds_read_b128 v[100:103], v230 offset:2048
    v_mfma_f32_16x16x32_bf16 v[56:59], v[88:91], v[184:187], v[56:59]
    ds_read_b128 v[104:107], v230 offset:4096
    v_mfma_f32_16x16x32_bf16 v[60:63], v[92:95], v[184:187], v[60:63]
    ds_read_b128 v[108:111], v230 offset:6144
    s_waitcnt lgkmcnt(8)
    v_mfma_f32_16x16x32_bf16 v[76:79], v[92:95], v[188:191], v[76:79]
    buffer_load_dwordx4 v212, s[40:43], s69 offen lds
    v_mfma_f32_16x16x32_bf16 v[72:75], v[88:91], v[188:191], v[72:75]
    ds_read_b64_tr_b16 v[180:181], v252 offset:20480
    ds_read_b64_tr_b16 v[182:183], v252 offset:20992
    v_mfma_f32_16x16x32_bf16 v[68:71], v[84:87], v[188:191], v[68:71]
    buffer_load_dwordx4 v213, s[40:43], s69 offen offset:1024 lds
    v_mfma_f32_16x16x32_bf16 v[64:67], v[80:83], v[188:191], v[64:67]
    s_waitcnt lgkmcnt(2)
    v_mfma_f32_16x16x32_bf16 v[16:19], v[96:99], v[176:179], v[16:19]
    ds_read_b64_tr_b16 v[184:185], v231 offset:28672
    ds_read_b64_tr_b16 v[186:187], v231 offset:29184
    ds_read_b64_tr_b16 v[188:189], v252 offset:28672
    v_mfma_f32_16x16x32_bf16 v[20:23], v[100:103], v[176:179], v[20:23]
    ds_read_b64_tr_b16 v[190:191], v252 offset:29184
    v_mfma_f32_16x16x32_bf16 v[24:27], v[104:107], v[176:179], v[24:27]
    ds_read_b128 a[40:43], v226 offset:0
    v_mfma_f32_16x16x32_bf16 v[28:31], v[108:111], v[176:179], v[28:31]
    ds_read_b128 a[44:47], v227 offset:0
    s_waitcnt lgkmcnt(6)
    v_mfma_f32_16x16x32_bf16 v[44:47], v[108:111], v[180:183], v[44:47]
    buffer_load_dwordx4 v214, s[40:43], s69 offen offset:2048 lds
    v_mfma_f32_16x16x32_bf16 v[40:43], v[104:107], v[180:183], v[40:43]
    v_mfma_f32_16x16x32_bf16 v[36:39], v[100:103], v[180:183], v[36:39]
    buffer_load_dwordx4 v215, s[40:43], s69 offen offset:3072 lds
    v_mfma_f32_16x16x32_bf16 v[32:35], v[96:99], v[180:183], v[32:35]
    s_add_u32 s68, s68, 128
    s_add_u32 m0, s76, 32768
    s_waitcnt vmcnt(8)
    s_barrier
    s_waitcnt lgkmcnt(4)
    v_mfma_f32_16x16x32_bf16 v[48:51], v[96:99], v[184:187], v[48:51]
    ds_read_b64_tr_b16 v[176:177], v231 offset:49152
    ds_read_b64_tr_b16 v[178:179], v231 offset:49664
    ds_read_b128 v[80:83], v229 offset:32768
    v_mfma_f32_16x16x32_bf16 v[52:55], v[100:103], v[184:187], v[52:55]
    ds_read_b128 v[84:87], v229 offset:34816
    v_mfma_f32_16x16x32_bf16 v[56:59], v[104:107], v[184:187], v[56:59]
    ds_read_b128 v[88:91], v229 offset:36864
    v_mfma_f32_16x16x32_bf16 v[60:63], v[108:111], v[184:187], v[60:63]
    ds_read_b128 v[92:95], v229 offset:38912
    s_waitcnt lgkmcnt(8)
    v_mfma_f32_16x16x32_bf16 v[76:79], v[108:111], v[188:191], v[76:79]
    buffer_load_dwordx4 v208, s[36:39], s68 offen lds
    v_mfma_f32_16x16x32_bf16 v[72:75], v[104:107], v[188:191], v[72:75]
    ds_read_b64_tr_b16 v[180:181], v252 offset:49152
    ds_read_b64_tr_b16 v[182:183], v252 offset:49664
    v_mfma_f32_16x16x32_bf16 v[68:71], v[100:103], v[188:191], v[68:71]
    buffer_load_dwordx4 v209, s[36:39], s68 offen offset:1024 lds
    v_mfma_f32_16x16x32_bf16 v[64:67], v[96:99], v[188:191], v[64:67]
    v_xor_b32 v229, 0x10000, v229
    s_waitcnt lgkmcnt(2)
    v_mfma_f32_16x16x32_bf16 v[16:19], v[80:83], v[176:179], v[16:19]
    ds_read_b64_tr_b16 v[184:185], v231 offset:57344
    ds_read_b64_tr_b16 v[186:187], v231 offset:57856
    ds_read_b64_tr_b16 v[188:189], v252 offset:57344
    v_mfma_f32_16x16x32_bf16 v[20:23], v[84:87], v[176:179], v[20:23]
    ds_read_b64_tr_b16 v[190:191], v252 offset:57856
    v_mfma_f32_16x16x32_bf16 v[24:27], v[88:91], v[176:179], v[24:27]
    ds_read_b128 a[48:51], v224 offset:32768
    v_mfma_f32_16x16x32_bf16 v[28:31], v[92:95], v[176:179], v[28:31]
    ds_read_b128 a[52:55], v225 offset:32768
    s_waitcnt lgkmcnt(6)
    v_mfma_f32_16x16x32_bf16 v[44:47], v[92:95], v[180:183], v[44:47]
    buffer_load_dwordx4 v210, s[36:39], s68 offen offset:2048 lds
    v_mfma_f32_16x16x32_bf16 v[40:43], v[88:91], v[180:183], v[40:43]
    v_xor_b32 v224, 0x10000, v224
    v_xor_b32 v225, 0x10000, v225
    v_mfma_f32_16x16x32_bf16 v[36:39], v[84:87], v[180:183], v[36:39]
    buffer_load_dwordx4 v211, s[36:39], s68 offen offset:3072 lds
    v_mfma_f32_16x16x32_bf16 v[32:35], v[80:83], v[180:183], v[32:35]
    s_add_u32 s69, s69, s70
    s_add_u32 m0, s77, 32768
    s_waitcnt lgkmcnt(4)
    v_mfma_f32_16x16x32_bf16 v[48:51], v[80:83], v[184:187], v[48:51]
    ds_read_b64_tr_b16 v[176:177], v231 offset:53248
    ds_read_b64_tr_b16 v[178:179], v231 offset:53760
    ds_read_b128 v[96:99], v230 offset:32768
    v_mfma_f32_16x16x32_bf16 v[52:55], v[84:87], v[184:187], v[52:55]
    ds_read_b128 v[100:103], v230 offset:34816
    v_mfma_f32_16x16x32_bf16 v[56:59], v[88:91], v[184:187], v[56:59]
    ds_read_b128 v[104:107], v230 offset:36864
    v_mfma_f32_16x16x32_bf16 v[60:63], v[92:95], v[184:187], v[60:63]
    ds_read_b128 v[108:111], v230 offset:38912
    s_waitcnt lgkmcnt(8)
    v_mfma_f32_16x16x32_bf16 v[76:79], v[92:95], v[188:191], v[76:79]
    buffer_load_dwordx4 v212, s[40:43], s69 offen lds
    v_mfma_f32_16x16x32_bf16 v[72:75], v[88:91], v[188:191], v[72:75]
    ds_read_b64_tr_b16 v[180:181], v252 offset:53248
    ds_read_b64_tr_b16 v[182:183], v252 offset:53760
    v_mfma_f32_16x16x32_bf16 v[68:71], v[84:87], v[188:191], v[68:71]
    buffer_load_dwordx4 v213, s[40:43], s69 offen offset:1024 lds
    v_mfma_f32_16x16x32_bf16 v[64:67], v[80:83], v[188:191], v[64:67]
    v_xor_b32 v230, 0x10000, v230
    s_waitcnt lgkmcnt(2)
    v_mfma_f32_16x16x32_bf16 v[16:19], v[96:99], v[176:179], v[16:19]
    ds_read_b64_tr_b16 v[184:185], v231 offset:61440
    ds_read_b64_tr_b16 v[186:187], v231 offset:61952
    ds_read_b64_tr_b16 v[188:189], v252 offset:61440
    v_mfma_f32_16x16x32_bf16 v[20:23], v[100:103], v[176:179], v[20:23]
    ds_read_b64_tr_b16 v[190:191], v252 offset:61952
    v_mfma_f32_16x16x32_bf16 v[24:27], v[104:107], v[176:179], v[24:27]
    ds_read_b128 a[56:59], v226 offset:32768
    v_mfma_f32_16x16x32_bf16 v[28:31], v[108:111], v[176:179], v[28:31]
    ds_read_b128 a[60:63], v227 offset:32768
    s_waitcnt lgkmcnt(6)
    v_mfma_f32_16x16x32_bf16 v[44:47], v[108:111], v[180:183], v[44:47]
    buffer_load_dwordx4 v214, s[40:43], s69 offen offset:2048 lds
    v_mfma_f32_16x16x32_bf16 v[40:43], v[104:107], v[180:183], v[40:43]
    v_xor_b32 v226, 0x10000, v226
    v_xor_b32 v227, 0x10000, v227
    v_mfma_f32_16x16x32_bf16 v[36:39], v[100:103], v[180:183], v[36:39]
    buffer_load_dwordx4 v215, s[40:43], s69 offen offset:3072 lds
    v_mfma_f32_16x16x32_bf16 v[32:35], v[96:99], v[180:183], v[32:35]
    v_xor_b32 v231, 0x10000, v231
    v_xor_b32 v252, 0x10000, v252
    s_add_u32 s68, s68, 128
    s_add_u32 m0, s76, 65536
    s_waitcnt vmcnt(8)
    s_barrier
    s_waitcnt lgkmcnt(4)
    v_mfma_f32_16x16x32_bf16 v[48:51], v[96:99], v[184:187], v[48:51]
    ds_read_b64_tr_b16 v[176:177], v231 offset:16384
    ds_read_b64_tr_b16 v[178:179], v231 offset:16896
    ds_read_b128 v[80:83], v229 offset:0
    v_mfma_f32_16x16x32_bf16 v[52:55], v[100:103], v[184:187], v[52:55]
    ds_read_b128 v[84:87], v229 offset:2048
    v_mfma_f32_16x16x32_bf16 v[56:59], v[104:107], v[184:187], v[56:59]
    ds_read_b128 v[88:91], v229 offset:4096
    v_mfma_f32_16x16x32_bf16 v[60:63], v[108:111], v[184:187], v[60:63]
    ds_read_b128 v[92:95], v229 offset:6144
    s_waitcnt lgkmcnt(8)
    v_mfma_f32_16x16x32_bf16 v[76:79], v[108:111], v[188:191], v[76:79]
    buffer_load_dwordx4 v208, s[36:39], s68 offen lds
    v_mfma_f32_16x16x32_bf16 v[72:75], v[104:107], v[188:191], v[72:75]
    ds_read_b64_tr_b16 v[180:181], v252 offset:16384
    ds_read_b64_tr_b16 v[182:183], v252 offset:16896
    v_mfma_f32_16x16x32_bf16 v[68:71], v[100:103], v[188:191], v[68:71]
    buffer_load_dwordx4 v209, s[36:39], s68 offen offset:1024 lds
    v_mfma_f32_16x16x32_bf16 v[64:67], v[96:99], v[188:191], v[64:67]
    s_waitcnt lgkmcnt(2)
    v_mfma_f32_16x16x32_bf16 v[16:19], v[80:83], v[176:179], v[16:19]
    ds_read_b64_tr_b16 v[184:185], v231 offset:24576
    ds_read_b64_tr_b16 v[186:187], v231 offset:25088
    ds_read_b64_tr_b16 v[188:189], v252 offset:24576
    v_mfma_f32_16x16x32_bf16 v[20:23], v[84:87], v[176:179], v[20:23]
    ds_read_b64_tr_b16 v[190:191], v252 offset:25088
    v_mfma_f32_16x16x32_bf16 v[24:27], v[88:91], v[176:179], v[24:27]
    ds_read_b128 a[64:67], v224 offset:0
    v_mfma_f32_16x16x32_bf16 v[28:31], v[92:95], v[176:179], v[28:31]
    ds_read_b128 a[68:71], v225 offset:0
    s_waitcnt lgkmcnt(6)
    v_mfma_f32_16x16x32_bf16 v[44:47], v[92:95], v[180:183], v[44:47]
    buffer_load_dwordx4 v210, s[36:39], s68 offen offset:2048 lds
    v_mfma_f32_16x16x32_bf16 v[40:43], v[88:91], v[180:183], v[40:43]
    v_mfma_f32_16x16x32_bf16 v[36:39], v[84:87], v[180:183], v[36:39]
    buffer_load_dwordx4 v211, s[36:39], s68 offen offset:3072 lds
    v_mfma_f32_16x16x32_bf16 v[32:35], v[80:83], v[180:183], v[32:35]
    s_add_u32 s69, s69, s70
    s_add_u32 m0, s77, 65536
    s_waitcnt lgkmcnt(4)
    v_mfma_f32_16x16x32_bf16 v[48:51], v[80:83], v[184:187], v[48:51]
    ds_read_b64_tr_b16 v[176:177], v231 offset:20480
    ds_read_b64_tr_b16 v[178:179], v231 offset:20992
    ds_read_b128 v[96:99], v230 offset:0
    v_mfma_f32_16x16x32_bf16 v[52:55], v[84:87], v[184:187], v[52:55]
    ds_read_b128 v[100:103], v230 offset:2048
    v_mfma_f32_16x16x32_bf16 v[56:59], v[88:91], v[184:187], v[56:59]
    ds_read_b128 v[104:107], v230 offset:4096
    v_mfma_f32_16x16x32_bf16 v[60:63], v[92:95], v[184:187], v[60:63]
    ds_read_b128 v[108:111], v230 offset:6144
    s_waitcnt lgkmcnt(8)
    v_mfma_f32_16x16x32_bf16 v[76:79], v[92:95], v[188:191], v[76:79]
    buffer_load_dwordx4 v212, s[40:43], s69 offen lds
    v_mfma_f32_16x16x32_bf16 v[72:75], v[88:91], v[188:191], v[72:75]
    ds_read_b64_tr_b16 v[180:181], v252 offset:20480
    ds_read_b64_tr_b16 v[182:183], v252 offset:20992
    v_mfma_f32_16x16x32_bf16 v[68:71], v[84:87], v[188:191], v[68:71]
    buffer_load_dwordx4 v213, s[40:43], s69 offen offset:1024 lds
    v_mfma_f32_16x16x32_bf16 v[64:67], v[80:83], v[188:191], v[64:67]
    s_waitcnt lgkmcnt(2)
    v_mfma_f32_16x16x32_bf16 v[16:19], v[96:99], v[176:179], v[16:19]
    ds_read_b64_tr_b16 v[184:185], v231 offset:28672
    ds_read_b64_tr_b16 v[186:187], v231 offset:29184
    ds_read_b64_tr_b16 v[188:189], v252 offset:28672
    v_mfma_f32_16x16x32_bf16 v[20:23], v[100:103], v[176:179], v[20:23]
    ds_read_b64_tr_b16 v[190:191], v252 offset:29184
    v_mfma_f32_16x16x32_bf16 v[24:27], v[104:107], v[176:179], v[24:27]
    ds_read_b128 a[72:75], v226 offset:0
    v_mfma_f32_16x16x32_bf16 v[28:31], v[108:111], v[176:179], v[28:31]
    ds_read_b128 a[76:79], v227 offset:0
    s_waitcnt lgkmcnt(6)
    v_mfma_f32_16x16x32_bf16 v[44:47], v[108:111], v[180:183], v[44:47]
    buffer_load_dwordx4 v214, s[40:43], s69 offen offset:2048 lds
    v_mfma_f32_16x16x32_bf16 v[40:43], v[104:107], v[180:183], v[40:43]
    v_mfma_f32_16x16x32_bf16 v[36:39], v[100:103], v[180:183], v[36:39]
    buffer_load_dwordx4 v215, s[40:43], s69 offen offset:3072 lds
    v_mfma_f32_16x16x32_bf16 v[32:35], v[96:99], v[180:183], v[32:35]
    s_add_u32 s68, s68, 128
    s_add_u32 m0, s76, 98304
    s_waitcnt vmcnt(8)
    s_barrier
    s_waitcnt lgkmcnt(4)
    v_mfma_f32_16x16x32_bf16 v[48:51], v[96:99], v[184:187], v[48:51]
    ds_read_b64_tr_b16 v[176:177], v231 offset:49152
    ds_read_b64_tr_b16 v[178:179], v231 offset:49664
    ds_read_b128 v[80:83], v229 offset:32768
    v_mfma_f32_16x16x32_bf16 v[52:55], v[100:103], v[184:187], v[52:55]
    ds_read_b128 v[84:87], v229 offset:34816
    v_mfma_f32_16x16x32_bf16 v[56:59], v[104:107], v[184:187], v[56:59]
    ds_read_b128 v[88:91], v229 offset:36864
    v_mfma_f32_16x16x32_bf16 v[60:63], v[108:111], v[184:187], v[60:63]
    ds_read_b128 v[92:95], v229 offset:38912
    s_waitcnt lgkmcnt(8)
    v_mfma_f32_16x16x32_bf16 v[76:79], v[108:111], v[188:191], v[76:79]
    buffer_load_dwordx4 v208, s[36:39], s68 offen lds
    v_mfma_f32_16x16x32_bf16 v[72:75], v[104:107], v[188:191], v[72:75]
    ds_read_b64_tr_b16 v[180:181], v252 offset:49152
    ds_read_b64_tr_b16 v[182:183], v252 offset:49664
    v_mfma_f32_16x16x32_bf16 v[68:71], v[100:103], v[188:191], v[68:71]
    buffer_load_dwordx4 v209, s[36:39], s68 offen offset:1024 lds
    v_mfma_f32_16x16x32_bf16 v[64:67], v[96:99], v[188:191], v[64:67]
    v_xor_b32 v229, 0x10000, v229
    s_waitcnt lgkmcnt(2)
    v_mfma_f32_16x16x32_bf16 v[16:19], v[80:83], v[176:179], v[16:19]
    ds_read_b64_tr_b16 v[184:185], v231 offset:57344
    ds_read_b64_tr_b16 v[186:187], v231 offset:57856
    ds_read_b64_tr_b16 v[188:189], v252 offset:57344
    v_mfma_f32_16x16x32_bf16 v[20:23], v[84:87], v[176:179], v[20:23]
    ds_read_b64_tr_b16 v[190:191], v252 offset:57856
    v_mfma_f32_16x16x32_bf16 v[24:27], v[88:91], v[176:179], v[24:27]
    ds_read_b128 a[80:83], v224 offset:32768
    v_mfma_f32_16x16x32_bf16 v[28:31], v[92:95], v[176:179], v[28:31]
    ds_read_b128 a[84:87], v225 offset:32768
    s_waitcnt lgkmcnt(6)
    v_mfma_f32_16x16x32_bf16 v[44:47], v[92:95], v[180:183], v[44:47]
    buffer_load_dwordx4 v210, s[36:39], s68 offen offset:2048 lds
    v_mfma_f32_16x16x32_bf16 v[40:43], v[88:91], v[180:183], v[40:43]
    v_xor_b32 v224, 0x10000, v224
    v_xor_b32 v225, 0x10000, v225
    v_mfma_f32_16x16x32_bf16 v[36:39], v[84:87], v[180:183], v[36:39]
    buffer_load_dwordx4 v211, s[36:39], s68 offen offset:3072 lds
    v_mfma_f32_16x16x32_bf16 v[32:35], v[80:83], v[180:183], v[32:35]
    s_add_u32 s69, s69, s70
    s_add_u32 m0, s77, 98304
    s_waitcnt lgkmcnt(4)
    v_mfma_f32_16x16x32_bf16 v[48:51], v[80:83], v[184:187], v[48:51]
    ds_read_b64_tr_b16 v[176:177], v231 offset:53248
    ds_read_b64_tr_b16 v[178:179], v231 offset:53760
    ds_read_b128 v[96:99], v230 offset:32768
    v_mfma_f32_16x16x32_bf16 v[52:55], v[84:87], v[184:187], v[52:55]
    ds_read_b128 v[100:103], v230 offset:34816
    v_mfma_f32_16x16x32_bf16 v[56:59], v[88:91], v[184:187], v[56:59]
    ds_read_b128 v[104:107], v230 offset:36864
    v_mfma_f32_16x16x32_bf16 v[60:63], v[92:95], v[184:187], v[60:63]
    ds_read_b128 v[108:111], v230 offset:38912
    s_waitcnt lgkmcnt(8)
    v_mfma_f32_16x16x32_bf16 v[76:79], v[92:95], v[188:191], v[76:79]
    buffer_load_dwordx4 v212, s[40:43], s69 offen lds
    v_mfma_f32_16x16x32_bf16 v[72:75], v[88:91], v[188:191], v[72:75]
    ds_read_b64_tr_b16 v[180:181], v252 offset:53248
    ds_read_b64_tr_b16 v[182:183], v252 offset:53760
    v_mfma_f32_16x16x32_bf16 v[68:71], v[84:87], v[188:191], v[68:71]
    buffer_load_dwordx4 v213, s[40:43], s69 offen offset:1024 lds
    v_mfma_f32_16x16x32_bf16 v[64:67], v[80:83], v[188:191], v[64:67]
    v_xor_b32 v230, 0x10000, v230
    s_waitcnt lgkmcnt(2)
    v_mfma_f32_16x16x32_bf16 v[16:19], v[96:99], v[176:179], v[16:19]
    ds_read_b64_tr_b16 v[184:185], v231 offset:61440
    ds_read_b64_tr_b16 v[186:187], v231 offset:61952
    ds_read_b64_tr_b16 v[188:189], v252 offset:61440
    v_mfma_f32_16x16x32_bf16 v[20:23], v[100:103], v[176:179], v[20:23]
    ds_read_b64_tr_b16 v[190:191], v252 offset:61952
    v_mfma_f32_16x16x32_bf16 v[24:27], v[104:107], v[176:179], v[24:27]
    ds_read_b128 a[88:91], v226 offset:32768
    v_mfma_f32_16x16x32_bf16 v[28:31], v[108:111], v[176:179], v[28:31]
    ds_read_b128 a[92:95], v227 offset:32768
    s_waitcnt lgkmcnt(6)
    v_mfma_f32_16x16x32_bf16 v[44:47], v[108:111], v[180:183], v[44:47]
    buffer_load_dwordx4 v214, s[40:43], s69 offen offset:2048 lds
    v_mfma_f32_16x16x32_bf16 v[40:43], v[104:107], v[180:183], v[40:43]
    v_xor_b32 v226, 0x10000, v226
    v_xor_b32 v227, 0x10000, v227
    v_mfma_f32_16x16x32_bf16 v[36:39], v[100:103], v[180:183], v[36:39]
    buffer_load_dwordx4 v215, s[40:43], s69 offen offset:3072 lds
    v_mfma_f32_16x16x32_bf16 v[32:35], v[96:99], v[180:183], v[32:35]
    v_xor_b32 v231, 0x10000, v231
    v_xor_b32 v252, 0x10000, v252
    s_xor_b32 s2, s63, 0
    s_add_u32 s2, s2, s60
    s_and_b32 s2, s2, 7
    s_mul_i32 s2, s2, 196608
    s_lshl_b32 s3, s62, 7
    s_add_u32 s2, s2, s3
    s_add_u32 m0, s81, 0
    s_waitcnt vmcnt(8)
    s_barrier
    s_waitcnt lgkmcnt(4)
    v_mfma_f32_16x16x32_bf16 v[48:51], v[96:99], v[184:187], v[48:51]
    ds_read_b64_tr_b16 v[176:177], v231 offset:16384
    ds_read_b64_tr_b16 v[178:179], v231 offset:16896
    ds_read_b128 v[80:83], v229 offset:0
    v_mfma_f32_16x16x32_bf16 v[52:55], v[100:103], v[184:187], v[52:55]
    ds_read_b128 v[84:87], v229 offset:2048
    v_mfma_f32_16x16x32_bf16 v[56:59], v[104:107], v[184:187], v[56:59]
    ds_read_b128 v[88:91], v229 offset:4096
    v_mfma_f32_16x16x32_bf16 v[60:63], v[108:111], v[184:187], v[60:63]
    ds_read_b128 v[92:95], v229 offset:6144
    s_waitcnt lgkmcnt(8)
    v_mfma_f32_16x16x32_bf16 v[76:79], v[108:111], v[188:191], v[76:79]
    buffer_load_dwordx4 v212, s[40:43], s2 offen lds
    v_mfma_f32_16x16x32_bf16 v[72:75], v[104:107], v[188:191], v[72:75]
    ds_read_b64_tr_b16 v[180:181], v252 offset:16384
    ds_read_b64_tr_b16 v[182:183], v252 offset:16896
    v_mfma_f32_16x16x32_bf16 v[68:71], v[100:103], v[188:191], v[68:71]
    buffer_load_dwordx4 v213, s[40:43], s2 offen offset:1024 lds
    v_mfma_f32_16x16x32_bf16 v[64:67], v[96:99], v[188:191], v[64:67]
    s_waitcnt lgkmcnt(2)
    v_mfma_f32_16x16x32_bf16 v[16:19], v[80:83], v[176:179], v[16:19]
    ds_read_b64_tr_b16 v[184:185], v231 offset:24576
    ds_read_b64_tr_b16 v[186:187], v231 offset:25088
    ds_read_b64_tr_b16 v[188:189], v252 offset:24576
    v_mfma_f32_16x16x32_bf16 v[20:23], v[84:87], v[176:179], v[20:23]
    ds_read_b64_tr_b16 v[190:191], v252 offset:25088
    v_mfma_f32_16x16x32_bf16 v[24:27], v[88:91], v[176:179], v[24:27]
    ds_read_b128 a[96:99], v224 offset:0
    v_mfma_f32_16x16x32_bf16 v[28:31], v[92:95], v[176:179], v[28:31]
    ds_read_b128 a[100:103], v225 offset:0
    s_waitcnt lgkmcnt(6)
    v_mfma_f32_16x16x32_bf16 v[44:47], v[92:95], v[180:183], v[44:47]
    buffer_load_dwordx4 v214, s[40:43], s2 offen offset:2048 lds
    v_mfma_f32_16x16x32_bf16 v[40:43], v[88:91], v[180:183], v[40:43]
    v_mfma_f32_16x16x32_bf16 v[36:39], v[84:87], v[180:183], v[36:39]
    buffer_load_dwordx4 v215, s[40:43], s2 offen offset:3072 lds
    v_mfma_f32_16x16x32_bf16 v[32:35], v[80:83], v[180:183], v[32:35]
    s_add_u32 s2, s2, 98304
    s_add_u32 m0, s81, 4096
    s_waitcnt lgkmcnt(4)
    v_mfma_f32_16x16x32_bf16 v[48:51], v[80:83], v[184:187], v[48:51]
    ds_read_b64_tr_b16 v[176:177], v231 offset:20480
    ds_read_b64_tr_b16 v[178:179], v231 offset:20992
    ds_read_b128 v[96:99], v230 offset:0
    v_mfma_f32_16x16x32_bf16 v[52:55], v[84:87], v[184:187], v[52:55]
    ds_read_b128 v[100:103], v230 offset:2048
    v_mfma_f32_16x16x32_bf16 v[56:59], v[88:91], v[184:187], v[56:59]
    ds_read_b128 v[104:107], v230 offset:4096
    v_mfma_f32_16x16x32_bf16 v[60:63], v[92:95], v[184:187], v[60:63]
    ds_read_b128 v[108:111], v230 offset:6144
    s_waitcnt lgkmcnt(8)
    v_mfma_f32_16x16x32_bf16 v[76:79], v[92:95], v[188:191], v[76:79]
    buffer_load_dwordx4 v212, s[40:43], s2 offen lds
    v_mfma_f32_16x16x32_bf16 v[72:75], v[88:91], v[188:191], v[72:75]
    ds_read_b64_tr_b16 v[180:181], v252 offset:20480
    ds_read_b64_tr_b16 v[182:183], v252 offset:20992
    v_mfma_f32_16x16x32_bf16 v[68:71], v[84:87], v[188:191], v[68:71]
    buffer_load_dwordx4 v213, s[40:43], s2 offen offset:1024 lds
    v_mfma_f32_16x16x32_bf16 v[64:67], v[80:83], v[188:191], v[64:67]
    s_waitcnt lgkmcnt(2)
    v_mfma_f32_16x16x32_bf16 v[16:19], v[96:99], v[176:179], v[16:19]
    ds_read_b64_tr_b16 v[184:185], v231 offset:28672
    ds_read_b64_tr_b16 v[186:187], v231 offset:29184
    ds_read_b64_tr_b16 v[188:189], v252 offset:28672
    v_mfma_f32_16x16x32_bf16 v[20:23], v[100:103], v[176:179], v[20:23]
    ds_read_b64_tr_b16 v[190:191], v252 offset:29184
    v_mfma_f32_16x16x32_bf16 v[24:27], v[104:107], v[176:179], v[24:27]
    ds_read_b128 a[104:107], v226 offset:0
    v_mfma_f32_16x16x32_bf16 v[28:31], v[108:111], v[176:179], v[28:31]
    ds_read_b128 a[108:111], v227 offset:0
    s_waitcnt lgkmcnt(6)
    v_mfma_f32_16x16x32_bf16 v[44:47], v[108:111], v[180:183], v[44:47]
    buffer_load_dwordx4 v214, s[40:43], s2 offen offset:2048 lds
    v_mfma_f32_16x16x32_bf16 v[40:43], v[104:107], v[180:183], v[40:43]
    v_mfma_f32_16x16x32_bf16 v[36:39], v[100:103], v[180:183], v[36:39]
    buffer_load_dwordx4 v215, s[40:43], s2 offen offset:3072 lds
    v_mfma_f32_16x16x32_bf16 v[32:35], v[96:99], v[180:183], v[32:35]
    s_xor_b32 s2, s63, 4
    s_add_u32 s2, s2, s60
    s_and_b32 s2, s2, 7
    s_mul_i32 s2, s2, 196608
    s_lshl_b32 s3, s62, 7
    s_add_u32 s2, s2, s3
    s_add_u32 m0, s81, 32768
    s_waitcnt vmcnt(8)
    s_barrier
    s_waitcnt lgkmcnt(4)
    v_mfma_f32_16x16x32_bf16 v[48:51], v[96:99], v[184:187], v[48:51]
    ds_read_b64_tr_b16 v[176:177], v231 offset:49152
    ds_read_b64_tr_b16 v[178:179], v231 offset:49664
    ds_read_b128 v[80:83], v229 offset:32768
    v_mfma_f32_16x16x32_bf16 v[52:55], v[100:103], v[184:187], v[52:55]
    ds_read_b128 v[84:87], v229 offset:34816
    v_mfma_f32_16x16x32_bf16 v[56:59], v[104:107], v[184:187], v[56:59]
    ds_read_b128 v[88:91], v229 offset:36864
    v_mfma_f32_16x16x32_bf16 v[60:63], v[108:111], v[184:187], v[60:63]
    ds_read_b128 v[92:95], v229 offset:38912
    s_waitcnt lgkmcnt(8)
    v_mfma_f32_16x16x32_bf16 v[76:79], v[108:111], v[188:191], v[76:79]
    buffer_load_dwordx4 v212, s[40:43], s2 offen lds
    v_mfma_f32_16x16x32_bf16 v[72:75], v[104:107], v[188:191], v[72:75]
    ds_read_b64_tr_b16 v[180:181], v252 offset:49152
    ds_read_b64_tr_b16 v[182:183], v252 offset:49664
    v_mfma_f32_16x16x32_bf16 v[68:71], v[100:103], v[188:191], v[68:71]
    buffer_load_dwordx4 v213, s[40:43], s2 offen offset:1024 lds
    v_mfma_f32_16x16x32_bf16 v[64:67], v[96:99], v[188:191], v[64:67]
    v_xor_b32 v229, 0x10000, v229
    s_waitcnt lgkmcnt(2)
    v_mfma_f32_16x16x32_bf16 v[16:19], v[80:83], v[176:179], v[16:19]
    ds_read_b64_tr_b16 v[184:185], v231 offset:57344
    ds_read_b64_tr_b16 v[186:187], v231 offset:57856
    ds_read_b64_tr_b16 v[188:189], v252 offset:57344
    v_mfma_f32_16x16x32_bf16 v[20:23], v[84:87], v[176:179], v[20:23]
    ds_read_b64_tr_b16 v[190:191], v252 offset:57856
    v_mfma_f32_16x16x32_bf16 v[24:27], v[88:91], v[176:179], v[24:27]
    ds_read_b128 a[112:115], v224 offset:32768
    v_mfma_f32_16x16x32_bf16 v[28:31], v[92:95], v[176:179], v[28:31]
    ds_read_b128 a[116:119], v225 offset:32768
    s_waitcnt lgkmcnt(6)
    v_mfma_f32_16x16x32_bf16 v[44:47], v[92:95], v[180:183], v[44:47]
    buffer_load_dwordx4 v214, s[40:43], s2 offen offset:2048 lds
    v_mfma_f32_16x16x32_bf16 v[40:43], v[88:91], v[180:183], v[40:43]
    v_xor_b32 v224, 0x10000, v224
    v_xor_b32 v225, 0x10000, v225
    v_mfma_f32_16x16x32_bf16 v[36:39], v[84:87], v[180:183], v[36:39]
    buffer_load_dwordx4 v215, s[40:43], s2 offen offset:3072 lds
    v_mfma_f32_16x16x32_bf16 v[32:35], v[80:83], v[180:183], v[32:35]
    s_add_u32 s2, s2, 98304
    s_add_u32 m0, s81, 36864
    s_waitcnt lgkmcnt(4)
    v_mfma_f32_16x16x32_bf16 v[48:51], v[80:83], v[184:187], v[48:51]
    ds_read_b64_tr_b16 v[176:177], v231 offset:53248
    ds_read_b64_tr_b16 v[178:179], v231 offset:53760
    ds_read_b128 v[96:99], v230 offset:32768
    v_mfma_f32_16x16x32_bf16 v[52:55], v[84:87], v[184:187], v[52:55]
    ds_read_b128 v[100:103], v230 offset:34816
    v_mfma_f32_16x16x32_bf16 v[56:59], v[88:91], v[184:187], v[56:59]
    ds_read_b128 v[104:107], v230 offset:36864
    v_mfma_f32_16x16x32_bf16 v[60:63], v[92:95], v[184:187], v[60:63]
    ds_read_b128 v[108:111], v230 offset:38912
    s_waitcnt lgkmcnt(8)
    v_mfma_f32_16x16x32_bf16 v[76:79], v[92:95], v[188:191], v[76:79]
    buffer_load_dwordx4 v212, s[40:43], s2 offen lds
    v_mfma_f32_16x16x32_bf16 v[72:75], v[88:91], v[188:191], v[72:75]
    ds_read_b64_tr_b16 v[180:181], v252 offset:53248
    ds_read_b64_tr_b16 v[182:183], v252 offset:53760
    v_mfma_f32_16x16x32_bf16 v[68:71], v[84:87], v[188:191], v[68:71]
    buffer_load_dwordx4 v213, s[40:43], s2 offen offset:1024 lds
    v_mfma_f32_16x16x32_bf16 v[64:67], v[80:83], v[188:191], v[64:67]
    v_xor_b32 v230, 0x10000, v230
    s_waitcnt lgkmcnt(2)
    v_mfma_f32_16x16x32_bf16 v[16:19], v[96:99], v[176:179], v[16:19]
    ds_read_b64_tr_b16 v[184:185], v231 offset:61440
    ds_read_b64_tr_b16 v[186:187], v231 offset:61952
    ds_read_b64_tr_b16 v[188:189], v252 offset:61440
    v_mfma_f32_16x16x32_bf16 v[20:23], v[100:103], v[176:179], v[20:23]
    ds_read_b64_tr_b16 v[190:191], v252 offset:61952
    v_mfma_f32_16x16x32_bf16 v[24:27], v[104:107], v[176:179], v[24:27]
    ds_read_b128 a[120:123], v226 offset:32768
    v_mfma_f32_16x16x32_bf16 v[28:31], v[108:111], v[176:179], v[28:31]
    ds_read_b128 a[124:127], v227 offset:32768
    s_waitcnt lgkmcnt(6)
    v_mfma_f32_16x16x32_bf16 v[44:47], v[108:111], v[180:183], v[44:47]
    buffer_load_dwordx4 v214, s[40:43], s2 offen offset:2048 lds
    v_mfma_f32_16x16x32_bf16 v[40:43], v[104:107], v[180:183], v[40:43]
    v_xor_b32 v226, 0x10000, v226
    v_xor_b32 v227, 0x10000, v227
    v_mfma_f32_16x16x32_bf16 v[36:39], v[100:103], v[180:183], v[36:39]
    buffer_load_dwordx4 v215, s[40:43], s2 offen offset:3072 lds
    v_mfma_f32_16x16x32_bf16 v[32:35], v[96:99], v[180:183], v[32:35]
    v_xor_b32 v231, 0x10000, v231
    v_xor_b32 v252, 0x10000, v252
    s_waitcnt lgkmcnt(0)
    v_mfma_f32_16x16x32_bf16 v[48:51], v[96:99], v[184:187], v[48:51]
    v_mfma_f32_16x16x32_bf16 v[52:55], v[100:103], v[184:187], v[52:55]
    v_mfma_f32_16x16x32_bf16 v[56:59], v[104:107], v[184:187], v[56:59]
    v_mfma_f32_16x16x32_bf16 v[60:63], v[108:111], v[184:187], v[60:63]
    v_mfma_f32_16x16x32_bf16 v[76:79], v[108:111], v[188:191], v[76:79]
    v_mfma_f32_16x16x32_bf16 v[72:75], v[104:107], v[188:191], v[72:75]
    v_mfma_f32_16x16x32_bf16 v[68:71], v[100:103], v[188:191], v[68:71]
    v_mfma_f32_16x16x32_bf16 v[64:67], v[96:99], v[188:191], v[64:67]
    s_barrier
    s_atomic_swap s66, s[44:45], s75
    v_pk_fma_f32 v[4:5], v[16:17], s[82:83], v[254:255]
    v_exp_f32 v4, v4 clamp
    v_exp_f32 v5, v5 clamp
    v_pk_fma_f32 v[6:7], v[18:19], s[82:83], v[254:255]
    v_exp_f32 v6, v6 clamp
    v_exp_f32 v7, v7 clamp
    v_max_f32 v4, v4, v16
    v_max_f32 v5, v5, v17
    v_pk_add_f32 v[4:5], v[4:5], s[86:87]
    v_cvt_pk_bf16_f32 v112, v4, v5
    v_pk_fma_f32 v[8:9], v[20:21], s[82:83], v[254:255]
    v_exp_f32 v8, v8 clamp
    v_exp_f32 v9, v9 clamp
    v_max_f32 v6, v6, v18
    v_max_f32 v7, v7, v19
    v_pk_add_f32 v[6:7], v[6:7], s[86:87]
    v_cvt_pk_bf16_f32 v113, v6, v7
    v_pk_fma_f32 v[10:11], v[22:23], s[82:83], v[254:255]
    v_exp_f32 v10, v10 clamp
    v_exp_f32 v11, v11 clamp
    v_max_f32 v8, v8, v20
    s_xor_b32 s2, s32, 0
    s_add_u32 m0, s81, 98304
    s_nop 0
    buffer_load_dwordx4 v220, s[52:55], s2 offen lds
    v_max_f32 v9, v9, v21
    v_pk_add_f32 v[8:9], v[8:9], s[86:87]
    v_cvt_pk_bf16_f32 v114, v8, v9
    v_pk_fma_f32 v[4:5], v[24:25], s[82:83], v[254:255]
    v_exp_f32 v4, v4 clamp
    v_exp_f32 v5, v5 clamp
    v_max_f32 v10, v10, v22
    v_max_f32 v11, v11, v23
    v_pk_add_f32 v[10:11], v[10:11], s[86:87]
    buffer_load_dwordx4 v221, s[52:55], s2 offen offset:1024 lds
    v_cvt_pk_bf16_f32 v115, v10, v11
    v_pk_fma_f32 v[6:7], v[26:27], s[82:83], v[254:255]
    v_exp_f32 v6, v6 clamp
    v_exp_f32 v7, v7 clamp
    v_max_f32 v4, v4, v24
    v_max_f32 v5, v5, v25
    v_pk_add_f32 v[4:5], v[4:5], s[86:87]
    v_cvt_pk_bf16_f32 v116, v4, v5
    v_pk_fma_f32 v[8:9], v[28:29], s[82:83], v[254:255]
    buffer_load_dwordx4 v222, s[52:55], s2 offen offset:2048 lds
    v_exp_f32 v8, v8 clamp
    v_exp_f32 v9, v9 clamp
    v_max_f32 v6, v6, v26
    v_max_f32 v7, v7, v27
    v_pk_add_f32 v[6:7], v[6:7], s[86:87]
    v_cvt_pk_bf16_f32 v117, v6, v7
    v_pk_fma_f32 v[10:11], v[30:31], s[82:83], v[254:255]
    v_exp_f32 v10, v10 clamp
    v_exp_f32 v11, v11 clamp
    buffer_load_dwordx4 v223, s[52:55], s2 offen offset:3072 lds
    v_max_f32 v8, v8, v28
    v_max_f32 v9, v9, v29
    v_pk_add_f32 v[8:9], v[8:9], s[86:87]
    v_cvt_pk_bf16_f32 v118, v8, v9
    v_max_f32 v10, v10, v30
    v_max_f32 v11, v11, v31
    v_pk_add_f32 v[10:11], v[10:11], s[86:87]
    v_cvt_pk_bf16_f32 v119, v10, v11
    v_cvt_pk_bf16_f32 v128, v48, v49
    s_add_u32 s2, s2, 32768
    s_add_u32 m0, s81, 102400
    s_nop 0
    buffer_load_dwordx4 v220, s[52:55], s2 offen lds
    v_cvt_pk_bf16_f32 v129, v50, v51
    v_cvt_pk_bf16_f32 v130, v52, v53
    v_cvt_pk_bf16_f32 v131, v54, v55
    v_cvt_pk_bf16_f32 v132, v56, v57
    v_cvt_pk_bf16_f32 v133, v58, v59
    v_cvt_pk_bf16_f32 v134, v60, v61
    v_cvt_pk_bf16_f32 v135, v62, v63
    v_cvt_pk_bf16_f32 v136, v64, v65
    v_cvt_pk_bf16_f32 v137, v66, v67
    buffer_load_dwordx4 v221, s[52:55], s2 offen offset:1024 lds
    v_cvt_pk_bf16_f32 v138, v68, v69
    v_cvt_pk_bf16_f32 v139, v70, v71
    v_cvt_pk_bf16_f32 v140, v72, v73
    v_cvt_pk_bf16_f32 v141, v74, v75
    v_cvt_pk_bf16_f32 v142, v76, v77
    v_cvt_pk_bf16_f32 v143, v78, v79
    v_pk_fma_f32 v[4:5], v[32:33], s[82:83], v[254:255]
    v_exp_f32 v4, v4 clamp
    v_exp_f32 v5, v5 clamp
    buffer_load_dwordx4 v222, s[52:55], s2 offen offset:2048 lds
    v_pk_fma_f32 v[6:7], v[34:35], s[82:83], v[254:255]
    v_exp_f32 v6, v6 clamp
    v_exp_f32 v7, v7 clamp
    v_max_f32 v4, v4, v32
    v_max_f32 v5, v5, v33
    v_pk_add_f32 v[4:5], v[4:5], s[86:87]
    v_cvt_pk_bf16_f32 v120, v4, v5
    v_pk_fma_f32 v[8:9], v[36:37], s[82:83], v[254:255]
    v_exp_f32 v8, v8 clamp
    buffer_load_dwordx4 v223, s[52:55], s2 offen offset:3072 lds
    v_exp_f32 v9, v9 clamp
    v_max_f32 v6, v6, v34
    v_max_f32_e64 v7, v7, v35
    v_pk_add_f32 v[6:7], v[6:7], s[86:87]
    v_cvt_pk_bf16_f32 v121, v6, v7
    v_pk_fma_f32 v[10:11], v[38:39], s[82:83], v[254:255]
    v_exp_f32 v10, v10 clamp
    v_exp_f32 v11, v11 clamp
    v_max_f32 v8, v8, v36
    s_xor_b32 s2, s33, 512
    s_add_u32 m0, s81, 65536
    s_nop 0
    buffer_load_dwordx4 v216, s[48:51], s2 offen lds
    v_max_f32_e64 v9, v9, v37
    v_pk_add_f32 v[8:9], v[8:9], s[86:87]
    v_cvt_pk_bf16_f32 v122, v8, v9
    v_pk_fma_f32 v[4:5], v[40:41], s[82:83], v[254:255]
    v_exp_f32 v4, v4 clamp
    v_exp_f32 v5, v5 clamp
    v_max_f32 v10, v10, v38
    v_max_f32 v11, v11, v39
    v_pk_add_f32 v[10:11], v[10:11], s[86:87]
    buffer_load_dwordx4 v217, s[48:51], s2 offen offset:1024 lds
    v_cvt_pk_bf16_f32 v123, v10, v11
    v_pk_fma_f32 v[6:7], v[42:43], s[82:83], v[254:255]
    v_exp_f32 v6, v6 clamp
    v_exp_f32 v7, v7 clamp
    v_max_f32 v4, v4, v40
    v_max_f32 v5, v5, v41
    v_pk_add_f32 v[4:5], v[4:5], s[86:87]
    v_cvt_pk_bf16_f32 v124, v4, v5
    v_pk_fma_f32 v[8:9], v[44:45], s[82:83], v[254:255]
    buffer_load_dwordx4 v218, s[48:51], s2 offen offset:2048 lds
    v_exp_f32 v8, v8 clamp
    v_exp_f32 v9, v9 clamp
    v_max_f32 v6, v6, v42
    v_max_f32 v7, v7, v43
    v_pk_add_f32 v[6:7], v[6:7], s[86:87]
    v_cvt_pk_bf16_f32 v125, v6, v7
    v_pk_fma_f32 v[10:11], v[46:47], s[82:83], v[254:255]
    v_exp_f32 v10, v10 clamp
    v_exp_f32 v11, v11 clamp
    buffer_load_dwordx4 v219, s[48:51], s2 offen offset:3072 lds
    v_max_f32 v8, v8, v44
    v_max_f32 v9, v9, v45
    v_pk_add_f32 v[8:9], v[8:9], s[86:87]
    v_cvt_pk_bf16_f32 v126, v8, v9
    v_max_f32 v10, v10, v46
    v_max_f32 v11, v11, v47
    v_pk_add_f32 v[10:11], v[10:11], s[86:87]
    v_cvt_pk_bf16_f32 v127, v10, v11
    v_mfma_f32_16x16x32_bf16 v[180:183], v[112:115], v[128:131], 0
    v_mfma_f32_16x16x32_bf16 v[180:183], v[116:119], v[132:135], v[180:183]
    v_mfma_f32_16x16x32_bf16 v[184:187], v[120:123], v[136:139], 0
    v_mfma_f32_16x16x32_bf16 v[184:187], v[124:127], v[140:143], v[184:187]
    v_mfma_f32_16x16x32_bf16 v[176:179], v[144:147], v[112:115], 0
    v_mfma_f32_16x16x32_bf16 v[176:179], v[144:147], v[116:119], v[176:179]
    v_mfma_f32_16x16x32_bf16 v[176:179], v[148:151], v[120:123], v[176:179]
    v_mfma_f32_16x16x32_bf16 v[176:179], v[148:151], v[124:127], v[176:179]
    s_nop 1
    ds_write_b128 v244, v[180:183] offset:0
    s_nop 0
    ds_write_b128 v244, v[184:187] offset:4096
    s_nop 2
    ds_write_b32 v246, v176
    s_add_u32 s2, s2, 32768
    s_add_u32 m0, s81, 69632
    s_nop 0
    buffer_load_dwordx4 v216, s[48:51], s2 offen lds
    buffer_load_dwordx4 v217, s[48:51], s2 offen offset:1024 lds
    s_waitcnt vmcnt(6)
    s_waitcnt lgkmcnt(0)
    s_barrier
    s_nop 0
    ds_read_b128 v[16:19], v245 offset:0
    ds_read_b128 v[20:23], v245 offset:1024
    ds_read_b32 v32, v247 offset:0
    ds_read_b32 v33, v247 offset:256
    ds_read_b32 v34, v247 offset:512
    ds_read_b32 v35, v247 offset:768
    ds_read_b64_tr_b16 v[80:81], v232 offset:0
    ds_read_b64_tr_b16 v[82:83], v232 offset:512
    ds_read_b64_tr_b16 v[84:85], v233 offset:0
    ds_read_b64_tr_b16 v[86:87], v233 offset:512
    ds_read_b64_tr_b16 a[128:129], v248 offset:0
    ds_read_b64_tr_b16 a[130:131], v248 offset:1024
    ds_read_b64_tr_b16 a[132:133], v249 offset:0
    ds_read_b64_tr_b16 a[134:135], v249 offset:1024
    ds_read_b64_tr_b16 a[136:137], v248 offset:2048
    s_waitcnt lgkmcnt(13)
    v_pk_add_f32 v[16:17], v[16:17], v[20:21]
    v_pk_add_f32 v[18:19], v[18:19], v[22:23]
    v_cvt_pk_bf16_f32 v16, v16, v17
    v_cvt_pk_bf16_f32 v17, v18, v19
    v_min_u32 v16, -2, v16
    v_min_u32 v17, -2, v17
    buffer_store_dwordx2 v[16:17], v253, s[44:47], s84 offen sc1
    s_waitcnt lgkmcnt(9)
    v_pk_add_f32 v[32:33], v[32:33], v[34:35]
    v_add_f32 v32, v32, v33
    v_min_u32 v32, -2, v32
    s_mov_b64 exec, 0xffff
    buffer_store_dword v32, v14, s[44:47], s85 offen sc1
    s_mov_b64 exec, -1
    s_nop 0
    ds_read_b64_tr_b16 a[138:139], v248 offset:3072
    ds_read_b64_tr_b16 a[140:141], v249 offset:2048
    ds_read_b64_tr_b16 a[142:143], v249 offset:3072
    ds_read_b64_tr_b16 a[144:145], v248 offset:4096
    ds_read_b64_tr_b16 a[146:147], v248 offset:5120
    ds_read_b64_tr_b16 a[148:149], v249 offset:4096
    ds_read_b64_tr_b16 a[150:151], v249 offset:5120
    ds_read_b64_tr_b16 a[152:153], v248 offset:6144
    ds_read_b64_tr_b16 a[154:155], v248 offset:7168
    ds_read_b64_tr_b16 a[156:157], v249 offset:6144
    ds_read_b64_tr_b16 a[158:159], v249 offset:7168
    buffer_load_dwordx4 v218, s[48:51], s2 offen offset:2048 lds
    buffer_load_dwordx4 v219, s[48:51], s2 offen offset:3072 lds
    ds_read_b64_tr_b16 v[88:89], v232 offset:2048
    ds_read_b64_tr_b16 v[90:91], v232 offset:2560
    ds_read_b64_tr_b16 v[92:93], v233 offset:2048
    ds_read_b64_tr_b16 v[94:95], v233 offset:2560
    s_barrier
    s_waitcnt lgkmcnt(15)
    v_mfma_f32_32x32x16_bf16 v[176:191], v[80:83], a[0:3], 1.0
    ds_read_b64_tr_b16 v[96:97], v232 offset:4096
    ds_read_b64_tr_b16 v[98:99], v232 offset:4608
    ds_read_b64_tr_b16 v[100:101], v233 offset:4096
    ds_read_b64_tr_b16 v[102:103], v233 offset:4608
    v_mfma_f32_32x32x16_bf16 v[192:207], v[84:87], a[0:3], 1.0
    ds_read_b64_tr_b16 a[160:161], v248 offset:8192
    ds_read_b64_tr_b16 a[162:163], v248 offset:9216
    s_xor_b32 s2, s32, 131072
    s_add_u32 m0, s81, 131072
    s_nop 0
    buffer_load_dwordx4 v220, s[52:55], s2 offen lds
    s_waitcnt lgkmcnt(6)
    v_mfma_f32_32x32x16_bf16 v[176:191], v[88:91], a[4:7], v[176:191]
    ds_read_b64_tr_b16 v[104:105], v232 offset:6144
    ds_read_b64_tr_b16 v[106:107], v232 offset:6656
    ds_read_b64_tr_b16 v[108:109], v233 offset:6144
    ds_read_b64_tr_b16 v[110:111], v233 offset:6656
    v_mfma_f32_32x32x16_bf16 v[192:207], v[92:95], a[4:7], v[192:207]
    ds_read_b64_tr_b16 a[164:165], v249 offset:8192
    ds_read_b64_tr_b16 a[166:167], v249 offset:9216
    buffer_load_dwordx4 v221, s[52:55], s2 offen offset:1024 lds
    s_waitcnt lgkmcnt(8)
    v_mfma_f32_32x32x16_bf16 v[176:191], v[96:99], a[8:11], v[176:191]
    ds_read_b64_tr_b16 v[80:81], v232 offset:8192
    ds_read_b64_tr_b16 v[82:83], v232 offset:8704
    ds_read_b64_tr_b16 v[84:85], v233 offset:8192
    ds_read_b64_tr_b16 v[86:87], v233 offset:8704
    v_mfma_f32_32x32x16_bf16 v[192:207], v[100:103], a[8:11], v[192:207]
    ds_read_b64_tr_b16 a[168:169], v248 offset:10240
    ds_read_b64_tr_b16 a[170:171], v248 offset:11264
    buffer_load_dwordx4 v222, s[52:55], s2 offen offset:2048 lds
    s_waitcnt lgkmcnt(8)
    v_mfma_f32_32x32x16_bf16 v[176:191], v[104:107], a[12:15], v[176:191]
    ds_read_b64_tr_b16 v[88:89], v232 offset:10240
    ds_read_b64_tr_b16 v[90:91], v232 offset:10752
    ds_read_b64_tr_b16 v[92:93], v233 offset:10240
    ds_read_b64_tr_b16 v[94:95], v233 offset:10752
    v_mfma_f32_32x32x16_bf16 v[192:207], v[108:111], a[12:15], v[192:207]
    ds_read_b64_tr_b16 a[172:173], v249 offset:10240
    ds_read_b64_tr_b16 a[174:175], v249 offset:11264
    buffer_load_dwordx4 v223, s[52:55], s2 offen offset:3072 lds
    s_waitcnt lgkmcnt(8)
    v_mfma_f32_32x32x16_bf16 v[176:191], v[80:83], a[16:19], v[176:191]
    ds_read_b64_tr_b16 v[96:97], v232 offset:12288
    ds_read_b64_tr_b16 v[98:99], v232 offset:12800
    ds_read_b64_tr_b16 v[100:101], v233 offset:12288
    ds_read_b64_tr_b16 v[102:103], v233 offset:12800
    v_mfma_f32_32x32x16_bf16 v[192:207], v[84:87], a[16:19], v[192:207]
    ds_read_b64_tr_b16 a[176:177], v248 offset:12288
    ds_read_b64_tr_b16 a[178:179], v248 offset:13312
    s_add_u32 s2, s2, 32768
    s_add_u32 m0, s81, 135168
    s_nop 0
    buffer_load_dwordx4 v220, s[52:55], s2 offen lds
    s_waitcnt lgkmcnt(8)
    v_mfma_f32_32x32x16_bf16 v[176:191], v[88:91], a[20:23], v[176:191]
    ds_read_b64_tr_b16 v[104:105], v232 offset:14336
    ds_read_b64_tr_b16 v[106:107], v232 offset:14848
    ds_read_b64_tr_b16 v[108:109], v233 offset:14336
    ds_read_b64_tr_b16 v[110:111], v233 offset:14848
    v_mfma_f32_32x32x16_bf16 v[192:207], v[92:95], a[20:23], v[192:207]
    ds_read_b64_tr_b16 a[180:181], v249 offset:12288
    ds_read_b64_tr_b16 a[182:183], v249 offset:13312
    buffer_load_dwordx4 v221, s[52:55], s2 offen offset:1024 lds
    s_waitcnt lgkmcnt(8)
    v_mfma_f32_32x32x16_bf16 v[176:191], v[96:99], a[24:27], v[176:191]
    ds_read_b64_tr_b16 v[80:81], v232 offset:16384
    ds_read_b64_tr_b16 v[82:83], v232 offset:16896
    ds_read_b64_tr_b16 v[84:85], v233 offset:16384
    ds_read_b64_tr_b16 v[86:87], v233 offset:16896
    v_mfma_f32_32x32x16_bf16 v[192:207], v[100:103], a[24:27], v[192:207]
    ds_read_b64_tr_b16 a[184:185], v248 offset:14336
    ds_read_b64_tr_b16 a[186:187], v248 offset:15360
    buffer_load_dwordx4 v222, s[52:55], s2 offen offset:2048 lds
    s_load_dwordx16 s[8:23], s[44:45], s71 glc
    s_waitcnt lgkmcnt(8)
    v_mfma_f32_32x32x16_bf16 v[176:191], v[104:107], a[28:31], v[176:191]
    ds_read_b64_tr_b16 v[88:89], v232 offset:18432
    ds_read_b64_tr_b16 v[90:91], v232 offset:18944
    ds_read_b64_tr_b16 v[92:93], v233 offset:18432
    ds_read_b64_tr_b16 v[94:95], v233 offset:18944
    v_mfma_f32_32x32x16_bf16 v[192:207], v[108:111], a[28:31], v[192:207]
    ds_read_b64_tr_b16 a[188:189], v249 offset:14336
    ds_read_b64_tr_b16 a[190:191], v249 offset:15360
    buffer_load_dwordx4 v223, s[52:55], s2 offen offset:3072 lds
    s_waitcnt lgkmcnt(8)
    v_mfma_f32_32x32x16_bf16 v[176:191], v[80:83], a[32:35], v[176:191]
    ds_read_b64_tr_b16 v[96:97], v232 offset:20480
    ds_read_b64_tr_b16 v[98:99], v232 offset:20992
    ds_read_b64_tr_b16 v[100:101], v233 offset:20480
    ds_read_b64_tr_b16 v[102:103], v233 offset:20992
    v_mfma_f32_32x32x16_bf16 v[192:207], v[84:87], a[32:35], v[192:207]
    s_waitcnt lgkmcnt(4)
    s_barrier
    v_mfma_f32_32x32x16_bf16 v[176:191], v[88:91], a[36:39], v[176:191]
    ds_read_b64_tr_b16 v[104:105], v232 offset:22528
    ds_read_b64_tr_b16 v[106:107], v232 offset:23040
    ds_read_b64_tr_b16 v[108:109], v233 offset:22528
    ds_read_b64_tr_b16 v[110:111], v233 offset:23040
    v_mfma_f32_32x32x16_bf16 v[192:207], v[92:95], a[36:39], v[192:207]
    s_xor_b32 s2, s33, 768
    s_add_u32 m0, s81, 98304
    s_nop 0
    buffer_load_dwordx4 v216, s[48:51], s2 offen lds
    s_waitcnt lgkmcnt(4)
    v_mfma_f32_32x32x16_bf16 v[176:191], v[96:99], a[40:43], v[176:191]
    ds_read_b64_tr_b16 v[80:81], v232 offset:24576
    ds_read_b64_tr_b16 v[82:83], v232 offset:25088
    ds_read_b64_tr_b16 v[84:85], v233 offset:24576
    ds_read_b64_tr_b16 v[86:87], v233 offset:25088
    v_mfma_f32_32x32x16_bf16 v[192:207], v[100:103], a[40:43], v[192:207]
    buffer_load_dwordx4 v217, s[48:51], s2 offen offset:1024 lds
    s_waitcnt lgkmcnt(4)
    v_mfma_f32_32x32x16_bf16 v[176:191], v[104:107], a[44:47], v[176:191]
    ds_read_b64_tr_b16 v[88:89], v232 offset:26624
    ds_read_b64_tr_b16 v[90:91], v232 offset:27136
    ds_read_b64_tr_b16 v[92:93], v233 offset:26624
    ds_read_b64_tr_b16 v[94:95], v233 offset:27136
    v_mfma_f32_32x32x16_bf16 v[192:207], v[108:111], a[44:47], v[192:207]
    buffer_load_dwordx4 v218, s[48:51], s2 offen offset:2048 lds
    s_waitcnt lgkmcnt(4)
    v_mfma_f32_32x32x16_bf16 v[176:191], v[80:83], a[48:51], v[176:191]
    ds_read_b64_tr_b16 v[96:97], v232 offset:28672
    ds_read_b64_tr_b16 v[98:99], v232 offset:29184
    ds_read_b64_tr_b16 v[100:101], v233 offset:28672
    ds_read_b64_tr_b16 v[102:103], v233 offset:29184
    v_mfma_f32_32x32x16_bf16 v[192:207], v[84:87], a[48:51], v[192:207]
    buffer_load_dwordx4 v219, s[48:51], s2 offen offset:3072 lds
    s_waitcnt lgkmcnt(4)
    v_mfma_f32_32x32x16_bf16 v[176:191], v[88:91], a[52:55], v[176:191]
    ds_read_b64_tr_b16 v[104:105], v232 offset:30720
    ds_read_b64_tr_b16 v[106:107], v232 offset:31232
    ds_read_b64_tr_b16 v[108:109], v233 offset:30720
    ds_read_b64_tr_b16 v[110:111], v233 offset:31232
    v_mfma_f32_32x32x16_bf16 v[192:207], v[92:95], a[52:55], v[192:207]
    s_add_u32 s2, s2, 32768
    s_add_u32 m0, s81, 102400
    s_nop 0
    buffer_load_dwordx4 v216, s[48:51], s2 offen lds
    s_waitcnt lgkmcnt(4)
    v_mfma_f32_32x32x16_bf16 v[176:191], v[96:99], a[56:59], v[176:191]
    ds_read_b64_tr_b16 v[80:81], v232 offset:32768
    ds_read_b64_tr_b16 v[82:83], v232 offset:33280
    ds_read_b64_tr_b16 v[84:85], v233 offset:32768
    ds_read_b64_tr_b16 v[86:87], v233 offset:33280
    v_mfma_f32_32x32x16_bf16 v[192:207], v[100:103], a[56:59], v[192:207]
    buffer_load_dwordx4 v217, s[48:51], s2 offen offset:1024 lds
    s_waitcnt lgkmcnt(4)
    v_mfma_f32_32x32x16_bf16 v[176:191], v[104:107], a[60:63], v[176:191]
    s_waitcnt lgkmcnt(0)
    ds_read_b64_tr_b16 v[88:89], v232 offset:34816
    ds_read_b64_tr_b16 v[90:91], v232 offset:35328
    ds_read_b64_tr_b16 v[92:93], v233 offset:34816
    ds_read_b64_tr_b16 v[94:95], v233 offset:35328
    s_xor_b32 s8, s8, s66
    s_xor_b32 s9, s9, s66
    s_xor_b32 s10, s10, s66
    s_xor_b32 s11, s11, s66
    v_mfma_f32_32x32x16_bf16 v[192:207], v[108:111], a[60:63], v[192:207]
    buffer_load_dwordx4 v218, s[48:51], s2 offen offset:2048 lds
    v_mfma_f32_32x32x16_bf16 v[176:191], v[80:83], a[64:67], v[176:191]
    ds_read_b64_tr_b16 v[96:97], v232 offset:36864
    ds_read_b64_tr_b16 v[98:99], v232 offset:37376
    ds_read_b64_tr_b16 v[100:101], v233 offset:36864
    ds_read_b64_tr_b16 v[102:103], v233 offset:37376
    s_xor_b32 s12, s12, s66
    s_xor_b32 s13, s13, s66
    s_xor_b32 s14, s14, s66
    s_xor_b32 s15, s15, s66
    v_mfma_f32_32x32x16_bf16 v[192:207], v[84:87], a[64:67], v[192:207]
    buffer_load_dwordx4 v219, s[48:51], s2 offen offset:3072 lds
    s_waitcnt vmcnt(8)
    s_barrier
    s_waitcnt lgkmcnt(4)
    v_mfma_f32_32x32x16_bf16 v[176:191], v[88:91], a[68:71], v[176:191]
    ds_read_b64_tr_b16 v[104:105], v232 offset:38912
    ds_read_b64_tr_b16 v[106:107], v232 offset:39424
    ds_read_b64_tr_b16 v[108:109], v233 offset:38912
    ds_read_b64_tr_b16 v[110:111], v233 offset:39424
    s_xor_b32 s16, s16, s66
    s_xor_b32 s17, s17, s66
    s_xor_b32 s18, s18, s66
    s_xor_b32 s19, s19, s66
    v_mfma_f32_32x32x16_bf16 v[192:207], v[92:95], a[68:71], v[192:207]
    ds_read_b64_tr_b16 a[192:193], v250 offset:0
    ds_read_b64_tr_b16 a[194:195], v250 offset:1024
    s_xor_b32 s2, s33, 0
    s_add_u32 m0, s81, 0
    s_nop 0
    buffer_load_dwordx4 v216, s[48:51], s2 offen lds
    s_waitcnt lgkmcnt(6)
    v_mfma_f32_32x32x16_bf16 v[176:191], v[96:99], a[72:75], v[176:191]
    ds_read_b64_tr_b16 v[80:81], v232 offset:40960
    ds_read_b64_tr_b16 v[82:83], v232 offset:41472
    ds_read_b64_tr_b16 v[84:85], v233 offset:40960
    ds_read_b64_tr_b16 v[86:87], v233 offset:41472
    s_xor_b32 s20, s20, s66
    s_xor_b32 s21, s21, s66
    s_xor_b32 s22, s22, s66
    s_xor_b32 s23, s23, s66
    v_mfma_f32_32x32x16_bf16 v[192:207], v[100:103], a[72:75], v[192:207]
    ds_read_b64_tr_b16 a[196:197], v251 offset:0
    ds_read_b64_tr_b16 a[198:199], v251 offset:1024
    buffer_load_dwordx4 v217, s[48:51], s2 offen offset:1024 lds
    s_waitcnt lgkmcnt(8)
    v_mfma_f32_32x32x16_bf16 v[176:191], v[104:107], a[76:79], v[176:191]
    ds_read_b64_tr_b16 v[88:89], v232 offset:43008
    ds_read_b64_tr_b16 v[90:91], v232 offset:43520
    ds_read_b64_tr_b16 v[92:93], v233 offset:43008
    ds_read_b64_tr_b16 v[94:95], v233 offset:43520
    s_or_b64 s[8:9], s[8:9], s[10:11]
    s_or_b64 s[8:9], s[8:9], s[12:13]
    s_or_b64 s[8:9], s[8:9], s[14:15]
    s_or_b64 s[8:9], s[8:9], s[16:17]
    v_mfma_f32_32x32x16_bf16 v[192:207], v[108:111], a[76:79], v[192:207]
    ds_read_b64_tr_b16 a[200:201], v250 offset:2048
    ds_read_b64_tr_b16 a[202:203], v250 offset:3072
    buffer_load_dwordx4 v218, s[48:51], s2 offen offset:2048 lds
    s_waitcnt lgkmcnt(8)
    v_mfma_f32_32x32x16_bf16 v[176:191], v[80:83], a[80:83], v[176:191]
    ds_read_b64_tr_b16 v[96:97], v232 offset:45056
    ds_read_b64_tr_b16 v[98:99], v232 offset:45568
    ds_read_b64_tr_b16 v[100:101], v233 offset:45056
    ds_read_b64_tr_b16 v[102:103], v233 offset:45568
    s_or_b64 s[8:9], s[8:9], s[18:19]
    s_or_b64 s[8:9], s[8:9], s[20:21]
    v_mfma_f32_32x32x16_bf16 v[192:207], v[84:87], a[80:83], v[192:207]
    ds_read_b64_tr_b16 a[204:205], v251 offset:2048
    ds_read_b64_tr_b16 a[206:207], v251 offset:3072
    buffer_load_dwordx4 v219, s[48:51], s2 offen offset:3072 lds
    s_or_b64 s[8:9], s[8:9], s[22:23]
    s_cbranch_scc0 L_clr_x
    s_mov_b32 s78, 131072
L_clr:
    s_sub_u32 s78, s78, 1
    s_cbranch_scc1 L_clr_x
    s_load_dwordx16 s[8:23], s[44:45], s71 glc
    s_waitcnt lgkmcnt(0)
    s_xor_b32 s8, s8, s66
    s_xor_b32 s9, s9, s66
    s_xor_b32 s10, s10, s66
    s_xor_b32 s11, s11, s66
    s_xor_b32 s12, s12, s66
    s_xor_b32 s13, s13, s66
    s_xor_b32 s14, s14, s66
    s_xor_b32 s15, s15, s66
    s_xor_b32 s16, s16, s66
    s_xor_b32 s17, s17, s66
    s_xor_b32 s18, s18, s66
    s_xor_b32 s19, s19, s66
    s_xor_b32 s20, s20, s66
    s_xor_b32 s21, s21, s66
    s_xor_b32 s22, s22, s66
    s_xor_b32 s23, s23, s66
    s_or_b64 s[8:9], s[8:9], s[10:11]
    s_or_b64 s[8:9], s[8:9], s[12:13]
    s_or_b64 s[8:9], s[8:9], s[14:15]
    s_or_b64 s[8:9], s[8:9], s[16:17]
    s_or_b64 s[8:9], s[8:9], s[18:19]
    s_or_b64 s[8:9], s[8:9], s[20:21]
    s_or_b64 s[8:9], s[8:9], s[22:23]
    s_cbranch_scc1 L_clr
L_clr_x:
    buffer_load_dword v164, v14, s[44:47], s31 offen offset:0 sc1
    buffer_load_dword v165, v14, s[44:47], s31 offen offset:256 sc1
    s_waitcnt lgkmcnt(8)
    v_mfma_f32_32x32x16_bf16 v[176:191], v[88:91], a[84:87], v[176:191]
    ds_read_b64_tr_b16 v[104:105], v232 offset:47104
    ds_read_b64_tr_b16 v[106:107], v232 offset:47616
    ds_read_b64_tr_b16 v[108:109], v233 offset:47104
    ds_read_b64_tr_b16 v[110:111], v233 offset:47616
    v_mfma_f32_32x32x16_bf16 v[192:207], v[92:95], a[84:87], v[192:207]
    ds_read_b64_tr_b16 a[208:209], v250 offset:4096
    ds_read_b64_tr_b16 a[210:211], v250 offset:5120
    buffer_load_dword v166, v14, s[44:47], s31 offen offset:512 sc1
    s_waitcnt lgkmcnt(8)
    v_mfma_f32_32x32x16_bf16 v[176:191], v[96:99], a[88:91], v[176:191]
    ds_read_b64_tr_b16 v[80:81], v232 offset:49152
    ds_read_b64_tr_b16 v[82:83], v232 offset:49664
    ds_read_b64_tr_b16 v[84:85], v233 offset:49152
    ds_read_b64_tr_b16 v[86:87], v233 offset:49664
    v_mfma_f32_32x32x16_bf16 v[192:207], v[100:103], a[88:91], v[192:207]
    ds_read_b64_tr_b16 a[212:213], v251 offset:4096
    ds_read_b64_tr_b16 a[214:215], v251 offset:5120
    buffer_load_dword v167, v14, s[44:47], s31 offen offset:768 sc1
    s_waitcnt lgkmcnt(8)
    v_mfma_f32_32x32x16_bf16 v[176:191], v[104:107], a[92:95], v[176:191]
    ds_read_b64_tr_b16 v[88:89], v232 offset:51200
    ds_read_b64_tr_b16 v[90:91], v232 offset:51712
    ds_read_b64_tr_b16 v[92:93], v233 offset:51200
    ds_read_b64_tr_b16 v[94:95], v233 offset:51712
    v_mfma_f32_32x32x16_bf16 v[192:207], v[108:111], a[92:95], v[192:207]
    ds_read_b64_tr_b16 a[216:217], v250 offset:6144
    ds_read_b64_tr_b16 a[218:219], v250 offset:7168
    s_xor_b32 s3, s30, 0
    buffer_load_dwordx4 v[16:19], v13, s[44:47], s3 offen offset:0 sc1
    s_waitcnt lgkmcnt(8)
    v_mfma_f32_32x32x16_bf16 v[176:191], v[80:83], a[96:99], v[176:191]
    ds_read_b64_tr_b16 v[96:97], v232 offset:53248
    ds_read_b64_tr_b16 v[98:99], v232 offset:53760
    ds_read_b64_tr_b16 v[100:101], v233 offset:53248
    ds_read_b64_tr_b16 v[102:103], v233 offset:53760
    v_mfma_f32_32x32x16_bf16 v[192:207], v[84:87], a[96:99], v[192:207]
    ds_read_b64_tr_b16 a[220:221], v251 offset:6144
    ds_read_b64_tr_b16 a[222:223], v251 offset:7168
    buffer_load_dwordx4 v[20:23], v13, s[44:47], s3 offen offset:1024 sc1
    s_waitcnt lgkmcnt(8)
    v_mfma_f32_32x32x16_bf16 v[176:191], v[88:91], a[100:103], v[176:191]
    ds_read_b64_tr_b16 v[104:105], v232 offset:55296
    ds_read_b64_tr_b16 v[106:107], v232 offset:55808
    ds_read_b64_tr_b16 v[108:109], v233 offset:55296
    ds_read_b64_tr_b16 v[110:111], v233 offset:55808
    v_mfma_f32_32x32x16_bf16 v[192:207], v[92:95], a[100:103], v[192:207]
    ds_read_b64_tr_b16 a[224:225], v250 offset:8192
    ds_read_b64_tr_b16 a[226:227], v250 offset:9216
    buffer_load_dwordx4 v[24:27], v13, s[44:47], s3 offen offset:2048 sc1
    s_waitcnt lgkmcnt(8)
    v_mfma_f32_32x32x16_bf16 v[176:191], v[96:99], a[104:107], v[176:191]
    ds_read_b64_tr_b16 v[80:81], v232 offset:57344
    ds_read_b64_tr_b16 v[82:83], v232 offset:57856
    ds_read_b64_tr_b16 v[84:85], v233 offset:57344
    ds_read_b64_tr_b16 v[86:87], v233 offset:57856
    v_mfma_f32_32x32x16_bf16 v[192:207], v[100:103], a[104:107], v[192:207]
    ds_read_b64_tr_b16 a[228:229], v251 offset:8192
    ds_read_b64_tr_b16 a[230:231], v251 offset:9216
    buffer_load_dwordx4 v[28:31], v13, s[44:47], s3 offen offset:3072 sc1
    s_waitcnt lgkmcnt(8)
    v_mfma_f32_32x32x16_bf16 v[176:191], v[104:107], a[108:111], v[176:191]
    ds_read_b64_tr_b16 v[88:89], v232 offset:59392
    ds_read_b64_tr_b16 v[90:91], v232 offset:59904
    ds_read_b64_tr_b16 v[92:93], v233 offset:59392
    ds_read_b64_tr_b16 v[94:95], v233 offset:59904
    v_mfma_f32_32x32x16_bf16 v[192:207], v[108:111], a[108:111], v[192:207]
    ds_read_b64_tr_b16 a[232:233], v250 offset:10240
    ds_read_b64_tr_b16 a[234:235], v250 offset:11264
    s_xor_b32 s3, s30, 4096
    buffer_load_dwordx4 v[32:35], v13, s[44:47], s3 offen offset:0 sc1
    s_waitcnt lgkmcnt(8)
    v_mfma_f32_32x32x16_bf16 v[176:191], v[80:83], a[112:115], v[176:191]
    ds_read_b64_tr_b16 v[96:97], v232 offset:61440
    ds_read_b64_tr_b16 v[98:99], v232 offset:61952
    ds_read_b64_tr_b16 v[100:101], v233 offset:61440
    ds_read_b64_tr_b16 v[102:103], v233 offset:61952
    v_mfma_f32_32x32x16_bf16 v[192:207], v[84:87], a[112:115], v[192:207]
    ds_read_b64_tr_b16 a[236:237], v251 offset:10240
    ds_read_b64_tr_b16 a[238:239], v251 offset:11264
    buffer_load_dwordx4 v[36:39], v13, s[44:47], s3 offen offset:1024 sc1
    s_waitcnt lgkmcnt(8)
    v_mfma_f32_32x32x16_bf16 v[176:191], v[88:91], a[116:119], v[176:191]
    ds_read_b64_tr_b16 v[104:105], v232 offset:63488
    ds_read_b64_tr_b16 v[106:107], v232 offset:64000
    ds_read_b64_tr_b16 v[108:109], v233 offset:63488
    ds_read_b64_tr_b16 v[110:111], v233 offset:64000
    v_mfma_f32_32x32x16_bf16 v[192:207], v[92:95], a[116:119], v[192:207]
    ds_read_b64_tr_b16 a[240:241], v250 offset:12288
    ds_read_b64_tr_b16 a[242:243], v250 offset:13312
    buffer_load_dwordx4 v[40:43], v13, s[44:47], s3 offen offset:2048 sc1
    s_waitcnt lgkmcnt(8)
    v_mfma_f32_32x32x16_bf16 v[176:191], v[96:99], a[120:123], v[176:191]
    ds_read_b64_tr_b16 a[244:245], v251 offset:12288
    ds_read_b64_tr_b16 a[246:247], v251 offset:13312
    v_mfma_f32_32x32x16_bf16 v[192:207], v[100:103], a[120:123], v[192:207]
    ds_read_b64_tr_b16 a[248:249], v250 offset:14336
    ds_read_b64_tr_b16 a[250:251], v250 offset:15360
    buffer_load_dwordx4 v[44:47], v13, s[44:47], s3 offen offset:3072 sc1
    s_waitcnt lgkmcnt(6)
    v_mfma_f32_32x32x16_bf16 v[176:191], v[104:107], a[124:127], v[176:191]
    ds_read_b64_tr_b16 a[252:253], v251 offset:14336
    ds_read_b64_tr_b16 a[254:255], v251 offset:15360
    v_mfma_f32_32x32x16_bf16 v[192:207], v[108:111], a[124:127], v[192:207]
    s_add_u32 s2, s2, 32768
    s_add_u32 m0, s81, 4096
    s_nop 0
    buffer_load_dwordx4 v216, s[48:51], s2 offen lds
    s_waitcnt lgkmcnt(0)
    s_barrier
    s_nop 2
    v_pk_fma_f32 v[4:5], v[176:177], s[82:83], v[254:255]
    v_exp_f32 v4, v4 clamp
    v_exp_f32 v5, v5 clamp
    v_pk_fma_f32 v[6:7], v[178:179], s[82:83], v[254:255]
    v_exp_f32 v6, v6 clamp
    v_exp_f32 v7, v7 clamp
    v_max_f32 v4, v4, v176
    v_max_f32 v5, v5, v177
    v_pk_add_f32 v[4:5], v[4:5], s[86:87]
    buffer_load_dwordx4 v217, s[48:51], s2 offen offset:1024 lds
    v_cvt_pk_bf16_f32 v112, v4, v5
    v_pk_fma_f32 v[8:9], v[180:181], s[82:83], v[254:255]
    v_exp_f32 v8, v8 clamp
    v_exp_f32 v9, v9 clamp
    v_max_f32 v6, v6, v178
    v_max_f32 v7, v7, v179
    v_pk_add_f32 v[6:7], v[6:7], s[86:87]
    v_cvt_pk_bf16_f32 v113, v6, v7
    v_pk_fma_f32 v[10:11], v[182:183], s[82:83], v[254:255]
    buffer_load_dwordx4 v218, s[48:51], s2 offen offset:2048 lds
    v_exp_f32 v10, v10 clamp
    v_exp_f32 v11, v11 clamp
    v_max_f32 v8, v8, v180
    v_max_f32_e64 v9, v9, v181
    v_pk_add_f32 v[8:9], v[8:9], s[86:87]
    v_cvt_pk_bf16_f32 v114, v8, v9
    v_pk_fma_f32 v[4:5], v[184:185], s[82:83], v[254:255]
    v_exp_f32 v4, v4 clamp
    v_exp_f32 v5, v5 clamp
    buffer_load_dwordx4 v219, s[48:51], s2 offen offset:3072 lds
    v_max_f32 v10, v10, v182
    v_max_f32 v11, v11, v183
    v_pk_add_f32 v[10:11], v[10:11], s[86:87]
    v_cvt_pk_bf16_f32 v115, v10, v11
    v_pk_fma_f32 v[6:7], v[186:187], s[82:83], v[254:255]
    v_exp_f32 v6, v6 clamp
    v_exp_f32 v7, v7 clamp
    v_max_f32 v4, v4, v184
    v_max_f32 v5, v5, v185
    s_mov_b32 m0, s24
    s_nop 0
    buffer_load_dwordx4 v216, s[36:39], s35 offen lds
    v_pk_add_f32 v[4:5], v[4:5], s[86:87]
    v_cvt_pk_bf16_f32 v116, v4, v5
    v_pk_fma_f32 v[8:9], v[188:189], s[82:83], v[254:255]
    v_exp_f32 v8, v8 clamp
    v_exp_f32 v9, v9 clamp
    v_max_f32 v6, v6, v186
    v_max_f32 v7, v7, v187
    v_pk_add_f32 v[6:7], v[6:7], s[86:87]
    v_cvt_pk_bf16_f32 v117, v6, v7
    buffer_load_dwordx4 v217, s[36:39], s35 offen offset:1024 lds
    v_pk_fma_f32 v[10:11], v[190:191], s[82:83], v[254:255]
    v_exp_f32 v10, v10 clamp
    v_exp_f32 v11, v11 clamp
    v_max_f32 v8, v8, v188
    v_max_f32 v9, v9, v189
    v_pk_add_f32 v[8:9], v[8:9], s[86:87]
    v_cvt_pk_bf16_f32 v118, v8, v9
    v_max_f32 v10, v10, v190
    v_max_f32 v11, v11, v191
    s_xor_b32 s2, s33, 256
    s_add_u32 m0, s81, 32768
    s_nop 0
    buffer_load_dwordx4 v216, s[48:51], s2 offen lds
    v_pk_add_f32 v[10:11], v[10:11], s[86:87]
    v_cvt_pk_bf16_f32 v119, v10, v11
    s_mov_b32 s78, 131072
    s_mov_b32 s74, s29
    s_mov_b32 s77, 1
    s_waitcnt vmcnt(11)
    v_mfma_f32_16x16x32_bf16 v[128:131], v[160:163], v[16:19], 0
    v_add_f32 v4, v164, v165
    v_add_f32 v5, v166, v167
    v_mfma_f32_16x16x32_bf16 v[128:131], v[160:163], v[20:23], v[128:131]
    v_add_f32 v4, v4, v5
    v_mov_b32 v5, v4
    v_mfma_f32_16x16x32_bf16 v[128:131], v[160:163], v[24:27], v[128:131]
    s_nop 0
    v_permlane32_swap_b32 v4, v5
    v_mfma_f32_16x16x32_bf16 v[128:131], v[160:163], v[28:31], v[128:131]
    v_add_f32 v4, v4, v5
    v_mov_b32 v5, v4
    s_waitcnt vmcnt(9)
    v_mfma_f32_16x16x32_bf16 v[128:131], v[160:163], v[32:35], v[128:131]
    s_nop 0
    v_permlane16_swap_b32 v4, v5
    v_mfma_f32_16x16x32_bf16 v[128:131], v[160:163], v[36:39], v[128:131]
    v_add_f32 v4, v4, v5
    v_cvt_pk_bf16_f32 v134, v4, v4
    s_waitcnt vmcnt(8)
    v_mfma_f32_16x16x32_bf16 v[128:131], v[160:163], v[40:43], v[128:131]
    s_waitcnt vmcnt(7)
    v_mfma_f32_16x16x32_bf16 v[128:131], v[160:163], v[44:47], v[128:131]
    s_nop 7
    v_cmp_u_f32 vcc, v4, v128
    s_nop 0
    s_cbranch_vccnz L_kvretry
L_kvok:
    ds_write_b16 v169, v134
    v_cvt_pk_bf16_f32 v132, v128, v129
    v_cvt_pk_bf16_f32 v133, v130, v131
    ds_write_b64 v168, v[132:133]
    v_pk_fma_f32 v[4:5], v[192:193], s[82:83], v[254:255]
    v_exp_f32 v4, v4 clamp
    v_exp_f32 v5, v5 clamp
    v_pk_fma_f32 v[6:7], v[194:195], s[82:83], v[254:255]
    v_exp_f32 v6, v6 clamp
    v_exp_f32 v7, v7 clamp
    v_max_f32 v4, v4, v192
    v_max_f32 v5, v5, v193
    v_pk_add_f32 v[4:5], v[4:5], s[86:87]
    buffer_load_dwordx4 v217, s[48:51], s2 offen offset:1024 lds
    v_cvt_pk_bf16_f32 v120, v4, v5
    v_pk_fma_f32 v[8:9], v[196:197], s[82:83], v[254:255]
    v_exp_f32 v8, v8 clamp
    v_exp_f32 v9, v9 clamp
    v_max_f32 v6, v6, v194
    v_max_f32 v7, v7, v195
    v_pk_add_f32 v[6:7], v[6:7], s[86:87]
    v_cvt_pk_bf16_f32 v121, v6, v7
    v_pk_fma_f32 v[10:11], v[198:199], s[82:83], v[254:255]
    buffer_load_dwordx4 v218, s[48:51], s2 offen offset:2048 lds
    v_exp_f32 v10, v10 clamp
    v_exp_f32 v11, v11 clamp
    v_max_f32 v8, v8, v196
    v_max_f32 v9, v9, v197
    v_pk_add_f32 v[8:9], v[8:9], s[86:87]
    v_cvt_pk_bf16_f32 v122, v8, v9
    v_pk_fma_f32 v[4:5], v[200:201], s[82:83], v[254:255]
    v_exp_f32 v4, v4 clamp
    v_exp_f32 v5, v5 clamp
    buffer_load_dwordx4 v219, s[48:51], s2 offen offset:3072 lds
    v_max_f32 v10, v10, v198
    v_max_f32 v11, v11, v199
    v_pk_add_f32 v[10:11], v[10:11], s[86:87]
    v_cvt_pk_bf16_f32 v123, v10, v11
    v_pk_fma_f32 v[6:7], v[202:203], s[82:83], v[254:255]
    v_exp_f32 v6, v6 clamp
    v_exp_f32 v7, v7 clamp
    v_max_f32 v4, v4, v200
    v_max_f32 v5, v5, v201
    s_add_u32 s2, s2, 32768
    s_add_u32 m0, s81, 36864
    s_nop 0
    buffer_load_dwordx4 v216, s[48:51], s2 offen lds
    s_waitcnt lgkmcnt(0)
    s_barrier
    s_nop 0
    ds_read_b128 v[128:131], v170 offset:0
    ds_read_b128 v[132:135], v171 offset:0
    ds_read_b128 v[136:139], v170 offset:1024
    ds_read_b128 v[140:143], v171 offset:1024
    v_pk_add_f32 v[4:5], v[4:5], s[86:87]
    v_cvt_pk_bf16_f32 v124, v4, v5
    v_pk_fma_f32 v[8:9], v[204:205], s[82:83], v[254:255]
    v_exp_f32 v8, v8 clamp
    v_exp_f32 v9, v9 clamp
    v_max_f32 v6, v6, v202
    v_max_f32 v7, v7, v203
    v_pk_add_f32 v[6:7], v[6:7], s[86:87]
    v_cvt_pk_bf16_f32 v125, v6, v7
    buffer_load_dwordx4 v217, s[48:51], s2 offen offset:1024 lds
    v_pk_fma_f32 v[10:11], v[206:207], s[82:83], v[254:255]
    v_exp_f32 v10, v10 clamp
    v_exp_f32 v11, v11 clamp
    v_max_f32 v8, v8, v204
    v_max_f32 v9, v9, v205
    v_pk_add_f32 v[8:9], v[8:9], s[86:87]
    v_cvt_pk_bf16_f32 v126, v8, v9
    v_max_f32 v10, v10, v206
    v_max_f32 v11, v11, v207
    buffer_load_dwordx4 v218, s[48:51], s2 offen offset:2048 lds
    v_pk_add_f32 v[10:11], v[10:11], s[86:87]
    v_cvt_pk_bf16_f32 v127, v10, v11
    s_waitcnt lgkmcnt(3)
    v_mfma_f32_32x32x16_bf16 v[16:31], v[128:131], v[112:115], 0
    buffer_load_dwordx4 v219, s[48:51], s2 offen offset:3072 lds
    s_waitcnt lgkmcnt(2)
    v_mfma_f32_32x32x16_bf16 v[32:47], v[132:135], v[116:119], 0
    s_waitcnt lgkmcnt(1)
    v_mfma_f32_32x32x16_bf16 v[48:63], v[136:139], v[120:123], 0
    s_waitcnt lgkmcnt(0)
    v_mfma_f32_32x32x16_bf16 v[64:79], v[140:143], v[124:127], 0
    s_load_dwordx4 s[8:11], s[44:45], s5 glc
    s_nop 3
    v_add_f32 v24, s86, v24
    v_rcp_f32 v24, v24
    s_nop 0
    v_pk_mul_f32 v[16:17], v[16:17], v[24:25] op_sel_hi:[1,0]
    v_pk_mul_f32 v[18:19], v[18:19], v[24:25] op_sel_hi:[1,0]
    v_pk_mul_f32 v[20:21], v[20:21], v[24:25] op_sel_hi:[1,0]
    v_pk_mul_f32 v[22:23], v[22:23], v[24:25] op_sel_hi:[1,0]
    v_cvt_pk_bf16_f32 v176, v16, v17
    v_cvt_pk_bf16_f32 v177, v18, v19
    v_cvt_pk_bf16_f32 v178, v20, v21
    v_cvt_pk_bf16_f32 v179, v22, v23
    buffer_store_dwordx4 v[176:179], v172, s[44:47], s28 offen offset:0 sc1
    v_add_f32 v32, s86, v32
    v_rcp_f32_e64 v32, v32
    s_nop 0
    v_pk_mul_f32 v[40:41], v[40:41], v[32:33] op_sel_hi:[1,0]
    v_pk_mul_f32 v[42:43], v[42:43], v[32:33] op_sel_hi:[1,0]
    v_pk_mul_f32 v[44:45], v[44:45], v[32:33] op_sel_hi:[1,0]
    v_pk_mul_f32 v[46:47], v[46:47], v[32:33] op_sel_hi:[1,0]
    v_cvt_pk_bf16_f32 v180, v40, v41
    v_cvt_pk_bf16_f32 v181, v42, v43
    v_cvt_pk_bf16_f32 v182, v44, v45
    v_cvt_pk_bf16_f32 v183, v46, v47
    buffer_store_dwordx4 v[180:183], v172, s[44:47], s28 offen offset:1024 sc1
    v_add_f32 v56, s86, v56
    v_rcp_f32_e64 v56, v56
    s_nop 0
    v_pk_mul_f32 v[48:49], v[48:49], v[56:57] op_sel_hi:[1,0]
    v_pk_mul_f32 v[50:51], v[50:51], v[56:57] op_sel_hi:[1,0]
    v_pk_mul_f32 v[52:53], v[52:53], v[56:57] op_sel_hi:[1,0]
    v_pk_mul_f32 v[54:55], v[54:55], v[56:57] op_sel_hi:[1,0]
    v_cvt_pk_bf16_f32 v184, v48, v49
    v_cvt_pk_bf16_f32 v185, v50, v51
    v_cvt_pk_bf16_f32 v186, v52, v53
    v_cvt_pk_bf16_f32 v187, v54, v55
    buffer_store_dwordx4 v[184:187], v172, s[44:47], s28 offen offset:2048 sc1
    v_add_f32 v64, s86, v64
    v_rcp_f32_e64 v64, v64
    s_nop 0
    v_pk_mul_f32 v[72:73], v[72:73], v[64:65] op_sel_hi:[1,0]
    v_pk_mul_f32 v[74:75], v[74:75], v[64:65] op_sel_hi:[1,0]
    v_pk_mul_f32 v[76:77], v[76:77], v[64:65] op_sel_hi:[1,0]
    v_pk_mul_f32 v[78:79], v[78:79], v[64:65] op_sel_hi:[1,0]
    v_cvt_pk_bf16_f32 v188, v72, v73
    v_cvt_pk_bf16_f32 v189, v74, v75
    v_cvt_pk_bf16_f32 v190, v76, v77
    v_cvt_pk_bf16_f32 v191, v78, v79
    buffer_store_dwordx4 v[188:191], v172, s[44:47], s28 offen offset:3072 sc1
    s_branch L_phase2
.p2align 12
L_phase2:
    s_waitcnt lgkmcnt(0)
    s_xor_b32 s8, s8, s66
    s_xor_b32 s9, s9, s66
    s_xor_b32 s10, s10, s66
    s_xor_b32 s11, s11, s66
    s_or_b64 s[8:9], s[8:9], s[10:11]
    s_cbranch_scc0 L_ph_x
    s_load_dwordx4 s[8:11], s[44:45], s5 glc
    s_waitcnt lgkmcnt(0)
    s_xor_b32 s8, s8, s66
    s_xor_b32 s9, s9, s66
    s_xor_b32 s10, s10, s66
    s_xor_b32 s11, s11, s66
    s_or_b64 s[8:9], s[8:9], s[10:11]
    s_cbranch_scc0 L_ph_x
    s_cmp_eq_u32 s77, 0
    s_cbranch_scc1 L_noflag
    s_waitcnt vmcnt(0)
    s_cmp_eq_u32 s77, 0
    s_cbranch_scc1 L_noflag
    s_atomic_swap s66, s[44:45], s74
    s_cmp_eq_u32 s77, 1
    s_mov_b32 s77, 0
    s_cbranch_scc1 L_noflag
    s_atomic_swap s66, s[44:45], s74 offset:1024
L_noflag:
    s_mov_b32 s78, 131072
L_ph:
    s_sub_u32 s78, s78, 1
    s_cbranch_scc1 L_ph_x
    s_load_dwordx4 s[8:11], s[44:45], s5 glc
    s_waitcnt lgkmcnt(0)
    s_xor_b32 s8, s8, s66
    s_xor_b32 s9, s9, s66
    s_xor_b32 s10, s10, s66
    s_xor_b32 s11, s11, s66
    s_or_b64 s[8:9], s[8:9], s[10:11]
    s_cbranch_scc1 L_ph
L_ph_x:
    buffer_load_dwordx4 a[0:3], v13, s[44:47], s34 offen offset:0 sc1
    buffer_load_dwordx4 a[4:7], v13, s[44:47], s34 offen offset:1024 sc1
    buffer_load_dwordx4 a[8:11], v13, s[44:47], s34 offen offset:2048 sc1
    s_and_b32 s72, s76, 8192
    s_lshr_b32 s72, s72, 1
    s_add_u32 s72, s72, 155648
    s_lshl_b32 s73, s80, 6
    v_xor_b32 v254, s73, v228
    v_add_u32 v254, s72, v254
    v_xor_b32 v255, 32, v254
    v_mov_b64 v[200:201], 0
    v_mov_b64 v[202:203], 0
    v_mov_b64 v[204:205], 0
    buffer_load_dwordx4 a[12:15], v13, s[44:47], s34 offen offset:3072 sc1
    v_mov_b64 v[206:207], 0
    v_mov_b32 v3, 0
    v_and_b32 v10, 48, v13
    v_lshlrev_b64 v[8:9], v10, v[2:3]
    s_mov_b32 exec_lo, 0xf
    s_mov_b32 exec_hi, 0xf00
    v_mov_b64 v[200:201], v[8:9]
    s_mov_b64 exec, -1
    s_mov_b32 exec_lo, 0xf0
    s_mov_b32 exec_hi, 0xf000
    v_mov_b64 v[202:203], v[8:9]
    s_mov_b64 exec, -1
    s_xor_b32 s34, s34, 4096
    buffer_load_dwordx4 a[16:19], v13, s[44:47], s34 offen offset:0 sc1
    s_mov_b32 exec_lo, 0xf0000
    s_mov_b32 exec_hi, 0xf000000
    v_mov_b64 v[204:205], v[8:9]
    s_mov_b64 exec, -1
    s_mov_b32 exec_lo, 0xf00000
    s_mov_b32 exec_hi, 0xf0000000
    v_mov_b64 v[206:207], v[8:9]
    s_mov_b64 exec, -1
    v_and_b32 v4, 31, v0
    v_lshrrev_b32 v5, 5, v0
    buffer_load_dwordx4 a[20:23], v13, s[44:47], s34 offen offset:1024 sc1
    v_lshlrev_b32 v251, 2, v4
    s_lshl_b32 s73, s60, 7
    s_add_u32 s73, s73, 147456
    v_lshl_add_u32 v246, v5, 4, s73
    v_add_u32 v244, s73, v251
    v_lshl_add_u32 v6, s25, 1, v251
    v_lshl_add_u32 v245, v5, 13, v6
    s_xor_b32 s72, s76, 4096
    s_add_u32 s72, s72, 131072
    v_add_u32 v248, s72, v13
    buffer_load_dwordx4 a[24:27], v13, s[44:47], s34 offen offset:2048 sc1
    v_xor_b32 v249, 4096, v248
    s_mul_i32 s84, s4, 6
    s_add_u32 s84, s84, s80
    s_and_b32 s72, s62, 1
    s_lshl_b32 s72, s72, 1
    s_and_b32 s73, s65, 3
    s_xor_b32 s72, s72, s73
    s_lshl2_add_u32 s84, s84, s72
    s_lshl_b32 s84, s84, 12
    s_add_u32 s84, s84, 1114112
    buffer_load_dwordx4 a[28:31], v13, s[44:47], s34 offen offset:3072 sc1
    s_lshl_b32 s85, s4, 7
    s_add_u32 s85, s85, 81920
    s_xor_b32 s34, s34, 12288
    buffer_load_dwordx4 a[32:35], v13, s[44:47], s34 offen offset:0 sc1
    buffer_load_dwordx4 a[36:39], v13, s[44:47], s34 offen offset:1024 sc1
    s_waitcnt vmcnt(10)
    s_cmp_eq_u32 s77, 0
    s_cbranch_scc1 L_noflag2
    s_atomic_swap s66, s[44:45], s74
    s_cmp_eq_u32 s77, 1
    s_mov_b32 s77, 0
    s_cbranch_scc1 L_noflag2
    s_atomic_swap s66, s[44:45], s74 offset:1024
L_noflag2:
    s_barrier
    ds_read_b128 v[192:195], v254
    ds_read_b128 v[196:199], v255
    ds_read_b128 v[80:83], v236 offset:0
    ds_read_b128 v[84:87], v240 offset:0
    ds_read_b128 v[88:91], v237 offset:0
    ds_read_b128 v[92:95], v241 offset:0
    ds_read_b128 v[96:99], v236 offset:8192
    ds_read_b128 v[100:103], v240 offset:8192
    s_waitcnt lgkmcnt(6)
    v_mfma_f32_32x32x16_bf16 v[16:31], v[192:195], v[200:203], 0
    v_mfma_f32_32x32x16_bf16 v[16:31], v[196:199], v[204:207], v[16:31]
    s_waitcnt vmcnt(9) lgkmcnt(4)
    v_mfma_f32_32x32x16_bf16 v[16:31], a[0:3], v[80:83], v[16:31]
    buffer_load_dwordx4 a[40:43], v13, s[44:47], s34 offen offset:2048 sc1
    v_mfma_f32_32x32x16_bf16 v[32:47], a[0:3], v[84:87], 0
    ds_read_b128 v[104:107], v237 offset:8192
    ds_read_b128 v[108:111], v241 offset:8192
    s_waitcnt vmcnt(9) lgkmcnt(4)
    v_mfma_f32_32x32x16_bf16 v[16:31], a[4:7], v[88:91], v[16:31]
    buffer_load_dwordx4 a[44:47], v13, s[44:47], s34 offen offset:3072 sc1
    v_mfma_f32_32x32x16_bf16 v[32:47], a[4:7], v[92:95], v[32:47]
    ds_read_b128 v[80:83], v238 offset:0
    ds_read_b128 v[84:87], v242 offset:0
    s_waitcnt vmcnt(9) lgkmcnt(4)
    v_mfma_f32_32x32x16_bf16 v[16:31], a[8:11], v[96:99], v[16:31]
    s_xor_b32 s34, s34, 4096
    buffer_load_dwordx4 a[48:51], v13, s[44:47], s34 offen offset:0 sc1
    v_mfma_f32_32x32x16_bf16 v[32:47], a[8:11], v[100:103], v[32:47]
    ds_read_b128 v[88:91], v239 offset:0
    ds_read_b128 v[92:95], v243 offset:0
    s_waitcnt vmcnt(9) lgkmcnt(4)
    v_mfma_f32_32x32x16_bf16 v[16:31], a[12:15], v[104:107], v[16:31]
    buffer_load_dwordx4 a[52:55], v13, s[44:47], s34 offen offset:1024 sc1
    v_mfma_f32_32x32x16_bf16 v[32:47], a[12:15], v[108:111], v[32:47]
    ds_read_b128 v[96:99], v238 offset:8192
    ds_read_b128 v[100:103], v242 offset:8192
    s_waitcnt vmcnt(9) lgkmcnt(4)
    v_mfma_f32_32x32x16_bf16 v[16:31], a[16:19], v[80:83], v[16:31]
    buffer_load_dwordx4 a[56:59], v13, s[44:47], s34 offen offset:2048 sc1
    v_mfma_f32_32x32x16_bf16 v[32:47], a[16:19], v[84:87], v[32:47]
    ds_read_b128 v[104:107], v239 offset:8192
    ds_read_b128 v[108:111], v243 offset:8192
    s_waitcnt vmcnt(9) lgkmcnt(4)
    v_mfma_f32_32x32x16_bf16 v[16:31], a[20:23], v[88:91], v[16:31]
    buffer_load_dwordx4 a[60:63], v13, s[44:47], s34 offen offset:3072 sc1
    v_mfma_f32_32x32x16_bf16 v[32:47], a[20:23], v[92:95], v[32:47]
    ds_read_b128 v[80:83], v236 offset:16384
    ds_read_b128 v[84:87], v240 offset:16384
    s_waitcnt vmcnt(9) lgkmcnt(4)
    v_mfma_f32_32x32x16_bf16 v[16:31], a[24:27], v[96:99], v[16:31]
    s_xor_b32 s34, s34, 28672
    buffer_load_dwordx4 a[64:67], v13, s[44:47], s34 offen offset:0 sc1
    v_mfma_f32_32x32x16_bf16 v[32:47], a[24:27], v[100:103], v[32:47]
    ds_read_b128 v[88:91], v237 offset:16384
    ds_read_b128 v[92:95], v241 offset:16384
    s_waitcnt vmcnt(9) lgkmcnt(4)
    v_mfma_f32_32x32x16_bf16 v[16:31], a[28:31], v[104:107], v[16:31]
    buffer_load_dwordx4 a[68:71], v13, s[44:47], s34 offen offset:1024 sc1
    v_mfma_f32_32x32x16_bf16 v[32:47], a[28:31], v[108:111], v[32:47]
    ds_read_b128 v[96:99], v236 offset:24576
    ds_read_b128 v[100:103], v240 offset:24576
    s_waitcnt vmcnt(9) lgkmcnt(4)
    v_mfma_f32_32x32x16_bf16 v[16:31], a[32:35], v[80:83], v[16:31]
    buffer_load_dwordx4 a[72:75], v13, s[44:47], s34 offen offset:2048 sc1
    v_mfma_f32_32x32x16_bf16 v[32:47], a[32:35], v[84:87], v[32:47]
    ds_read_b128 v[104:107], v237 offset:24576
    ds_read_b128 v[108:111], v241 offset:24576
    s_waitcnt vmcnt(9) lgkmcnt(4)
    v_mfma_f32_32x32x16_bf16 v[16:31], a[36:39], v[88:91], v[16:31]
    buffer_load_dwordx4 a[76:79], v13, s[44:47], s34 offen offset:3072 sc1
    v_mfma_f32_32x32x16_bf16 v[32:47], a[36:39], v[92:95], v[32:47]
    ds_read_b128 v[80:83], v238 offset:16384
    ds_read_b128 v[84:87], v242 offset:16384
    s_waitcnt vmcnt(9) lgkmcnt(4)
    v_mfma_f32_32x32x16_bf16 v[16:31], a[40:43], v[96:99], v[16:31]
    s_xor_b32 s34, s34, 4096
    buffer_load_dwordx4 a[80:83], v13, s[44:47], s34 offen offset:0 sc1
    v_mfma_f32_32x32x16_bf16 v[32:47], a[40:43], v[100:103], v[32:47]
    ds_read_b128 v[88:91], v239 offset:16384
    ds_read_b128 v[92:95], v243 offset:16384
    s_waitcnt vmcnt(9) lgkmcnt(4)
    v_mfma_f32_32x32x16_bf16 v[16:31], a[44:47], v[104:107], v[16:31]
    buffer_load_dwordx4 a[84:87], v13, s[44:47], s34 offen offset:1024 sc1
    v_mfma_f32_32x32x16_bf16 v[32:47], a[44:47], v[108:111], v[32:47]
    ds_read_b128 v[96:99], v238 offset:24576
    ds_read_b128 v[100:103], v242 offset:24576
    s_waitcnt vmcnt(9) lgkmcnt(4)
    v_mfma_f32_32x32x16_bf16 v[16:31], a[48:51], v[80:83], v[16:31]
    buffer_load_dwordx4 a[88:91], v13, s[44:47], s34 offen offset:2048 sc1
    v_mfma_f32_32x32x16_bf16 v[32:47], a[48:51], v[84:87], v[32:47]
    ds_read_b128 v[104:107], v239 offset:24576
    ds_read_b128 v[108:111], v243 offset:24576
    s_waitcnt vmcnt(9) lgkmcnt(4)
    v_mfma_f32_32x32x16_bf16 v[16:31], a[52:55], v[88:91], v[16:31]
    buffer_load_dwordx4 a[92:95], v13, s[44:47], s34 offen offset:3072 sc1
    v_mfma_f32_32x32x16_bf16 v[32:47], a[52:55], v[92:95], v[32:47]
    ds_read_b128 v[80:83], v236 offset:32768
    ds_read_b128 v[84:87], v240 offset:32768
    s_load_dwordx8 s[8:15], s[44:45], s5 offset:512 glc
    s_waitcnt vmcnt(9) lgkmcnt(4)
    v_mfma_f32_32x32x16_bf16 v[16:31], a[56:59], v[96:99], v[16:31]
    s_xor_b32 s34, s34, 12288
    buffer_load_dwordx4 a[96:99], v13, s[44:47], s34 offen offset:0 sc1
    v_mfma_f32_32x32x16_bf16 v[32:47], a[56:59], v[100:103], v[32:47]
    ds_read_b128 v[88:91], v237 offset:32768
    ds_read_b128 v[92:95], v241 offset:32768
    s_waitcnt vmcnt(9) lgkmcnt(4)
    v_mfma_f32_32x32x16_bf16 v[16:31], a[60:63], v[104:107], v[16:31]
    buffer_load_dwordx4 a[100:103], v13, s[44:47], s34 offen offset:1024 sc1
    v_mfma_f32_32x32x16_bf16 v[32:47], a[60:63], v[108:111], v[32:47]
    ds_read_b128 v[96:99], v236 offset:40960
    ds_read_b128 v[100:103], v240 offset:40960
    s_waitcnt vmcnt(9) lgkmcnt(4)
    v_mfma_f32_32x32x16_bf16 v[16:31], a[64:67], v[80:83], v[16:31]
    buffer_load_dwordx4 a[104:107], v13, s[44:47], s34 offen offset:2048 sc1
    v_mfma_f32_32x32x16_bf16 v[32:47], a[64:67], v[84:87], v[32:47]
    ds_read_b128 v[104:107], v237 offset:40960
    ds_read_b128 v[108:111], v241 offset:40960
    s_waitcnt vmcnt(9) lgkmcnt(4)
    v_mfma_f32_32x32x16_bf16 v[16:31], a[68:71], v[88:91], v[16:31]
    buffer_load_dwordx4 a[108:111], v13, s[44:47], s34 offen offset:3072 sc1
    v_mfma_f32_32x32x16_bf16 v[32:47], a[68:71], v[92:95], v[32:47]
    ds_read_b128 v[80:83], v238 offset:32768
    ds_read_b128 v[84:87], v242 offset:32768
    s_waitcnt vmcnt(9) lgkmcnt(4)
    v_mfma_f32_32x32x16_bf16 v[16:31], a[72:75], v[96:99], v[16:31]
    s_xor_b32 s34, s34, 4096
    buffer_load_dwordx4 a[112:115], v13, s[44:47], s34 offen offset:0 sc1
    v_mfma_f32_32x32x16_bf16 v[32:47], a[72:75], v[100:103], v[32:47]
    ds_read_b128 v[88:91], v239 offset:32768
    ds_read_b128 v[92:95], v243 offset:32768
    s_waitcnt vmcnt(9) lgkmcnt(4)
    v_mfma_f32_32x32x16_bf16 v[16:31], a[76:79], v[104:107], v[16:31]
    buffer_load_dwordx4 a[116:119], v13, s[44:47], s34 offen offset:1024 sc1
    v_mfma_f32_32x32x16_bf16 v[32:47], a[76:79], v[108:111], v[32:47]
    ds_read_b128 v[96:99], v238 offset:40960
    ds_read_b128 v[100:103], v242 offset:40960
    s_waitcnt vmcnt(9) lgkmcnt(4)
    v_mfma_f32_32x32x16_bf16 v[16:31], a[80:83], v[80:83], v[16:31]
    buffer_load_dwordx4 a[120:123], v13, s[44:47], s34 offen offset:2048 sc1
    v_mfma_f32_32x32x16_bf16 v[32:47], a[80:83], v[84:87], v[32:47]
    ds_read_b128 v[104:107], v239 offset:40960
    ds_read_b128 v[108:111], v243 offset:40960
    s_waitcnt vmcnt(9) lgkmcnt(4)
    v_mfma_f32_32x32x16_bf16 v[16:31], a[84:87], v[88:91], v[16:31]
    buffer_load_dwordx4 a[124:127], v13, s[44:47], s34 offen offset:3072 sc1
    v_mfma_f32_32x32x16_bf16 v[32:47], a[84:87], v[92:95], v[32:47]
    s_waitcnt lgkmcnt(0)
    s_xor_b32 s8, s8, s66
    s_xor_b32 s9, s9, s66
    s_xor_b32 s10, s10, s66
    s_xor_b32 s11, s11, s66
    s_xor_b32 s12, s12, s66
    s_or_b32 s8, s8, s12
    s_or_b64 s[8:9], s[8:9], s[10:11]
    ds_read_b128 v[80:83], v236 offset:49152
    ds_read_b128 v[84:87], v240 offset:49152
    s_cbranch_scc1 L_slow
    s_waitcnt vmcnt(9)
    v_mfma_f32_32x32x16_bf16 v[16:31], a[88:91], v[96:99], v[16:31]
    buffer_load_dword v2, v251, s[44:47], s85 offen sc1
    buffer_load_dwordx4 v[112:115], v13, s[44:47], s84 offen offset:0 sc1
    v_mfma_f32_32x32x16_bf16 v[32:47], a[88:91], v[100:103], v[32:47]
    ds_read_b128 v[88:91], v237 offset:49152
    ds_read_b128 v[92:95], v241 offset:49152
    s_waitcnt vmcnt(10)
    v_mfma_f32_32x32x16_bf16 v[16:31], a[92:95], v[104:107], v[16:31]
    buffer_load_dwordx4 v[116:119], v13, s[44:47], s84 offen offset:1024 sc1
    v_mfma_f32_32x32x16_bf16 v[32:47], a[92:95], v[108:111], v[32:47]
    ds_read_b128 v[96:99], v236 offset:57344
    ds_read_b128 v[100:103], v240 offset:57344
    s_waitcnt vmcnt(10) lgkmcnt(4)
    v_mfma_f32_32x32x16_bf16 v[16:31], a[96:99], v[80:83], v[16:31]
    buffer_load_dwordx4 v[120:123], v13, s[44:47], s84 offen offset:2048 sc1
    v_mfma_f32_32x32x16_bf16 v[32:47], a[96:99], v[84:87], v[32:47]
    ds_read_b128 v[104:107], v237 offset:57344
    ds_read_b128 v[108:111], v241 offset:57344
    s_waitcnt vmcnt(10) lgkmcnt(4)
    v_mfma_f32_32x32x16_bf16 v[16:31], a[100:103], v[88:91], v[16:31]
    buffer_load_dwordx4 v[124:127], v13, s[44:47], s84 offen offset:3072 sc1
    v_mfma_f32_32x32x16_bf16 v[32:47], a[100:103], v[92:95], v[32:47]
    ds_read_b128 v[80:83], v238 offset:49152
    ds_read_b128 v[84:87], v242 offset:49152
    s_waitcnt vmcnt(10) lgkmcnt(4)
    v_mfma_f32_32x32x16_bf16 v[16:31], a[104:107], v[96:99], v[16:31]
    s_xor_b32 s84, s84, 4096
    buffer_load_dwordx4 v[128:131], v13, s[44:47], s84 offen offset:0 sc1
    v_mfma_f32_32x32x16_bf16 v[32:47], a[104:107], v[100:103], v[32:47]
    ds_read_b128 v[88:91], v239 offset:49152
    ds_read_b128 v[92:95], v243 offset:49152
    s_waitcnt vmcnt(10) lgkmcnt(4)
    v_mfma_f32_32x32x16_bf16 v[16:31], a[108:111], v[104:107], v[16:31]
    buffer_load_dwordx4 v[132:135], v13, s[44:47], s84 offen offset:1024 sc1
    v_mfma_f32_32x32x16_bf16 v[32:47], a[108:111], v[108:111], v[32:47]
    ds_read_b128 v[96:99], v238 offset:57344
    ds_read_b128 v[100:103], v242 offset:57344
    s_waitcnt vmcnt(10) lgkmcnt(4)
    v_mfma_f32_32x32x16_bf16 v[16:31], a[112:115], v[80:83], v[16:31]
    buffer_load_dwordx4 v[136:139], v13, s[44:47], s84 offen offset:2048 sc1
    v_mfma_f32_32x32x16_bf16 v[32:47], a[112:115], v[84:87], v[32:47]
    ds_read_b128 v[104:107], v239 offset:57344
    ds_read_b128 v[108:111], v243 offset:57344
    s_waitcnt vmcnt(10) lgkmcnt(4)
    v_mfma_f32_32x32x16_bf16 v[16:31], a[116:119], v[88:91], v[16:31]
    buffer_load_dwordx4 v[140:143], v13, s[44:47], s84 offen offset:3072 sc1
    v_mfma_f32_32x32x16_bf16 v[32:47], a[116:119], v[92:95], v[32:47]
    s_waitcnt vmcnt(10) lgkmcnt(2)
    v_mfma_f32_32x32x16_bf16 v[16:31], a[120:123], v[96:99], v[16:31]
    s_xor_b32 s84, s84, 12288
    buffer_load_dwordx4 v[144:147], v13, s[44:47], s84 offen offset:0 sc1
    v_mfma_f32_32x32x16_bf16 v[32:47], a[120:123], v[100:103], v[32:47]
    s_waitcnt vmcnt(10) lgkmcnt(0)
    v_mfma_f32_32x32x16_bf16 v[16:31], a[124:127], v[104:107], v[16:31]
    buffer_load_dwordx4 v[148:151], v13, s[44:47], s84 offen offset:1024 sc1
    v_mfma_f32_32x32x16_bf16 v[32:47], a[124:127], v[108:111], v[32:47]
L_2b:
    s_waitcnt vmcnt(9)
    v_mfma_f32_32x32x16_bf16 v[64:79], v[112:115], a[132:135], 0
    buffer_load_dwordx4 v[152:155], v13, s[44:47], s84 offen offset:2048 sc1
    v_mfma_f32_32x32x16_bf16 v[48:63], v[112:115], a[128:131], 0
    ds_write_b32 v244, v2
    s_waitcnt vmcnt(9)
    v_mfma_f32_32x32x16_bf16 v[64:79], v[116:119], a[140:143], v[64:79]
    buffer_load_dwordx4 v[156:159], v13, s[44:47], s84 offen offset:3072 sc1
    v_mfma_f32_32x32x16_bf16 v[48:63], v[116:119], a[136:139], v[48:63]
    ds_read_b128 v[176:179], v246 offset:0
    ds_read_b128 v[180:183], v246 offset:32
    s_waitcnt vmcnt(9)
    v_mfma_f32_32x32x16_bf16 v[64:79], v[120:123], a[148:151], v[64:79]
    s_xor_b32 s84, s84, 4096
    buffer_load_dwordx4 v[160:163], v13, s[44:47], s84 offen offset:0 sc1
    v_mfma_f32_32x32x16_bf16 v[48:63], v[120:123], a[144:147], v[48:63]
    ds_read_b128 v[184:187], v246 offset:64
    ds_read_b128 v[188:191], v246 offset:96
    s_waitcnt vmcnt(9)
    v_mfma_f32_32x32x16_bf16 v[64:79], v[124:127], a[156:159], v[64:79]
    buffer_load_dwordx4 v[164:167], v13, s[44:47], s84 offen offset:1024 sc1
    v_mfma_f32_32x32x16_bf16 v[48:63], v[124:127], a[152:155], v[48:63]
    s_waitcnt vmcnt(9)
    v_mfma_f32_32x32x16_bf16 v[64:79], v[128:131], a[164:167], v[64:79]
    buffer_load_dwordx4 v[168:171], v13, s[44:47], s84 offen offset:2048 sc1
    s_waitcnt lgkmcnt(0)
    v_mul_f32 v32, v32, v176
    v_mfma_f32_32x32x16_bf16 v[48:63], v[128:131], a[160:163], v[48:63]
    v_mul_f32 v33, v33, v177
    v_mul_f32 v34, v34, v178
    v_mul_f32 v35, v35, v179
    v_mul_f32 v36, v36, v180
    v_mul_f32 v37, v37, v181
    s_waitcnt vmcnt(9)
    v_mfma_f32_32x32x16_bf16 v[64:79], v[132:135], a[172:175], v[64:79]
    buffer_load_dwordx4 v[172:175], v13, s[44:47], s84 offen offset:3072 sc1
    v_mul_f32 v38, v38, v182
    v_mul_f32 v39, v39, v183
    v_mul_f32 v40, v40, v184
    v_mul_f32 v41, v41, v185
    v_mul_f32 v42, v42, v186
    v_mfma_f32_32x32x16_bf16 v[48:63], v[132:135], a[168:171], v[48:63]
    v_mul_f32 v43, v43, v187
    v_mul_f32 v44, v44, v188
    v_mul_f32 v45, v45, v189
    v_mul_f32 v46, v46, v190
    v_mul_f32 v47, v47, v191
    s_waitcnt vmcnt(9)
    v_mfma_f32_32x32x16_bf16 v[64:79], v[136:139], a[180:183], v[64:79]
    v_mul_f32 v16, v16, v176
    v_mul_f32 v17, v17, v177
    v_mul_f32 v18, v18, v178
    v_mul_f32 v19, v19, v179
    v_mul_f32 v20, v20, v180
    s_waitcnt vmcnt(8)
    v_mfma_f32_32x32x16_bf16 v[64:79], v[140:143], a[188:191], v[64:79]
    v_mul_f32 v21, v21, v181
    v_mul_f32 v22, v22, v182
    v_mul_f32 v23, v23, v183
    v_mul_f32 v24, v24, v184
    v_mul_f32 v25, v25, v185
    s_waitcnt vmcnt(7)
    v_mfma_f32_32x32x16_bf16 v[64:79], v[144:147], a[196:199], v[64:79]
    v_mul_f32 v26, v26, v186
    v_mul_f32 v27, v27, v187
    v_mul_f32 v28, v28, v188
    v_mul_f32 v29, v29, v189
    v_mul_f32 v30, v30, v190
    s_waitcnt vmcnt(6)
    v_mfma_f32_32x32x16_bf16 v[64:79], v[148:151], a[204:207], v[64:79]
    v_mul_f32 v31, v31, v191
    v_sub_f32 v176, 1.0, v176
    v_sub_f32 v177, 1.0, v177
    v_sub_f32 v178, 1.0, v178
    v_sub_f32 v179, 1.0, v179
    s_waitcnt vmcnt(5)
    v_mfma_f32_32x32x16_bf16 v[64:79], v[152:155], a[212:215], v[64:79]
    v_sub_f32 v180, 1.0, v180
    v_sub_f32 v181, 1.0, v181
    v_sub_f32 v182, 1.0, v182
    v_sub_f32 v183, 1.0, v183
    v_sub_f32 v184, 1.0, v184
    s_waitcnt vmcnt(4)
    v_mfma_f32_32x32x16_bf16 v[64:79], v[156:159], a[220:223], v[64:79]
    v_sub_f32 v185, 1.0, v185
    v_sub_f32 v186, 1.0, v186
    v_sub_f32 v187, 1.0, v187
    v_sub_f32 v188, 1.0, v188
    v_sub_f32 v189, 1.0, v189
    s_waitcnt vmcnt(3)
    v_mfma_f32_32x32x16_bf16 v[64:79], v[160:163], a[228:231], v[64:79]
    v_sub_f32 v190, 1.0, v190
    v_sub_f32 v191, 1.0, v191
    s_waitcnt vmcnt(2)
    v_mfma_f32_32x32x16_bf16 v[64:79], v[164:167], a[236:239], v[64:79]
    s_waitcnt vmcnt(1)
    v_mfma_f32_32x32x16_bf16 v[64:79], v[168:171], a[244:247], v[64:79]
    s_waitcnt vmcnt(0)
    v_mfma_f32_32x32x16_bf16 v[64:79], v[172:175], a[252:255], v[64:79]
    s_nop 4
    v_mfma_f32_32x32x16_bf16 v[48:63], v[136:139], a[176:179], v[48:63]
    s_nop 4
    v_mfma_f32_32x32x16_bf16 v[48:63], v[140:143], a[184:187], v[48:63]
    v_fmac_f32 v32, v64, v176
    v_fmac_f32 v33, v65, v177
    v_fmac_f32 v34, v66, v178
    v_fmac_f32 v35, v67, v179
    ds_write_b128 v248, v[32:35] offset:0
    v_mfma_f32_32x32x16_bf16 v[48:63], v[144:147], a[192:195], v[48:63]
    v_fmac_f32 v36, v68, v180
    v_fmac_f32 v37, v69, v181
    v_fmac_f32 v38, v70, v182
    v_fmac_f32 v39, v71, v183
    ds_write_b128 v248, v[36:39] offset:1024
    v_mfma_f32_32x32x16_bf16 v[48:63], v[148:151], a[200:203], v[48:63]
    v_fmac_f32 v40, v72, v184
    v_fmac_f32 v41, v73, v185
    v_fmac_f32 v42, v74, v186
    v_fmac_f32 v43, v75, v187
    ds_write_b128 v248, v[40:43] offset:2048
    v_mfma_f32_32x32x16_bf16 v[48:63], v[152:155], a[208:211], v[48:63]
    v_fmac_f32 v44, v76, v188
    v_fmac_f32 v45, v77, v189
    v_fmac_f32 v46, v78, v190
    v_fmac_f32 v47, v79, v191
    ds_write_b128 v248, v[44:47] offset:3072
    v_mfma_f32_32x32x16_bf16 v[48:63], v[156:159], a[216:219], v[48:63]
    s_waitcnt lgkmcnt(0)
    s_barrier
    ds_read_b128 v[80:83], v249 offset:0
    ds_read_b128 v[84:87], v249 offset:1024
    ds_read_b128 v[88:91], v249 offset:2048
    ds_read_b128 v[92:95], v249 offset:3072
    v_mfma_f32_32x32x16_bf16 v[48:63], v[160:163], a[224:227], v[48:63]
    s_lshl_b32 s72, s4, 16
    v_mfma_f32_32x32x16_bf16 v[48:63], v[164:167], a[232:235], v[48:63]
    s_waitcnt lgkmcnt(3)
    v_add_f32 v16, v16, v80
    v_add_f32 v17, v17, v81
    v_add_f32 v18, v18, v82
    v_add_f32 v19, v19, v83
    v_mfma_f32_32x32x16_bf16 v[48:63], v[168:171], a[240:243], v[48:63]
    s_waitcnt lgkmcnt(2)
    v_add_f32 v20, v20, v84
    v_add_f32 v21, v21, v85
    v_add_f32 v22, v22, v86
    v_add_f32 v23, v23, v87
    v_mfma_f32_32x32x16_bf16 v[48:63], v[172:175], a[248:251], v[48:63]
    s_waitcnt lgkmcnt(1)
    v_add_f32 v24, v24, v88
    v_add_f32 v25, v25, v89
    v_add_f32 v26, v26, v90
    v_add_f32 v27, v27, v91
    s_waitcnt lgkmcnt(0)
    v_add_f32 v28, v28, v92
    v_add_f32 v29, v29, v93
    v_add_f32 v30, v30, v94
    v_add_f32 v31, v31, v95
    s_nop 1
    v_pk_fma_f32 v[16:17], v[48:49], v[176:177], v[16:17]
    v_pk_fma_f32 v[18:19], v[50:51], v[178:179], v[18:19]
    s_add_u32 s73, s72, 4096
    buffer_store_dword v16, v245, s[56:59], s72 offen offset:0 sc1
    buffer_store_dword v17, v245, s[56:59], s72 offen offset:2048 sc1
    buffer_store_dword v18, v245, s[56:59], s73 offen offset:0 sc1
    buffer_store_dword v19, v245, s[56:59], s73 offen offset:2048 sc1
    s_add_u32 s72, s72, 16384
    v_pk_fma_f32 v[20:21], v[52:53], v[180:181], v[20:21]
    v_pk_fma_f32 v[22:23], v[54:55], v[182:183], v[22:23]
    s_add_u32 s73, s72, 4096
    buffer_store_dword v20, v245, s[56:59], s72 offen offset:0 sc1
    buffer_store_dword v21, v245, s[56:59], s72 offen offset:2048 sc1
    buffer_store_dword v22, v245, s[56:59], s73 offen offset:0 sc1
    buffer_store_dword v23, v245, s[56:59], s73 offen offset:2048 sc1
    s_add_u32 s72, s72, 16384
    v_pk_fma_f32 v[24:25], v[56:57], v[184:185], v[24:25]
    v_pk_fma_f32 v[26:27], v[58:59], v[186:187], v[26:27]
    s_add_u32 s73, s72, 4096
    buffer_store_dword v24, v245, s[56:59], s72 offen offset:0 sc1
    buffer_store_dword v25, v245, s[56:59], s72 offen offset:2048 sc1
    buffer_store_dword v26, v245, s[56:59], s73 offen offset:0 sc1
    buffer_store_dword v27, v245, s[56:59], s73 offen offset:2048 sc1
    s_add_u32 s72, s72, 16384
    v_pk_fma_f32 v[28:29], v[60:61], v[188:189], v[28:29]
    v_pk_fma_f32 v[30:31], v[62:63], v[190:191], v[30:31]
    s_add_u32 s73, s72, 4096
    buffer_store_dword v28, v245, s[56:59], s72 offen offset:0 sc1
    buffer_store_dword v29, v245, s[56:59], s72 offen offset:2048 sc1
    buffer_store_dword v30, v245, s[56:59], s73 offen offset:0 sc1
    buffer_store_dword v31, v245, s[56:59], s73 offen offset:2048 sc1
    s_lshl2_add_u32 s72, s65, s60
    s_lshl_b32 s72, s72, 5
    s_add_u32 s72, s72, s64
    s_cmp_eq_u32 s72, 31
    s_cbranch_scc0 L_fin
    s_mov_b64 exec, 1
    buffer_store_dword v12, v1, s[44:47], 0 offen sc1
    s_mov_b64 exec, -1
L_fin:
    s_endpgm
L_slow:
    s_load_dwordx8 s[8:15], s[44:45], s5 offset:512 glc
    s_waitcnt vmcnt(9)
    v_mfma_f32_32x32x16_bf16 v[16:31], a[88:91], v[96:99], v[16:31]
    v_mfma_f32_32x32x16_bf16 v[32:47], a[88:91], v[100:103], v[32:47]
    ds_read_b128 v[88:91], v237 offset:49152
    ds_read_b128 v[92:95], v241 offset:49152
    s_waitcnt vmcnt(8)
    v_mfma_f32_32x32x16_bf16 v[16:31], a[92:95], v[104:107], v[16:31]
    v_mfma_f32_32x32x16_bf16 v[32:47], a[92:95], v[108:111], v[32:47]
    ds_read_b128 v[96:99], v236 offset:57344
    ds_read_b128 v[100:103], v240 offset:57344
    s_waitcnt vmcnt(7) lgkmcnt(4)
    v_mfma_f32_32x32x16_bf16 v[16:31], a[96:99], v[80:83], v[16:31]
    v_mfma_f32_32x32x16_bf16 v[32:47], a[96:99], v[84:87], v[32:47]
    ds_read_b128 v[104:107], v237 offset:57344
    ds_read_b128 v[108:111], v241 offset:57344
    s_waitcnt vmcnt(6) lgkmcnt(4)
    v_mfma_f32_32x32x16_bf16 v[16:31], a[100:103], v[88:91], v[16:31]
    v_mfma_f32_32x32x16_bf16 v[32:47], a[100:103], v[92:95], v[32:47]
    ds_read_b128 v[80:83], v238 offset:49152
    ds_read_b128 v[84:87], v242 offset:49152
    s_waitcnt vmcnt(5) lgkmcnt(4)
    v_mfma_f32_32x32x16_bf16 v[16:31], a[104:107], v[96:99], v[16:31]
    v_mfma_f32_32x32x16_bf16 v[32:47], a[104:107], v[100:103], v[32:47]
    s_waitcnt lgkmcnt(0)
    s_xor_b32 s8, s8, s66
    s_xor_b32 s9, s9, s66
    s_xor_b32 s10, s10, s66
    s_xor_b32 s11, s11, s66
    s_xor_b32 s12, s12, s66
    s_or_b32 s8, s8, s12
    s_or_b64 s[8:9], s[8:9], s[10:11]
    ds_read_b128 v[88:91], v239 offset:49152
    ds_read_b128 v[92:95], v243 offset:49152
    s_cbranch_scc1 L_slow0
    buffer_load_dword v2, v251, s[44:47], s85 offen sc1
    buffer_load_dwordx4 v[112:115], v13, s[44:47], s84 offen offset:0 sc1
    buffer_load_dwordx4 v[116:119], v13, s[44:47], s84 offen offset:1024 sc1
    s_waitcnt vmcnt(7)
    v_mfma_f32_32x32x16_bf16 v[16:31], a[108:111], v[104:107], v[16:31]
    v_mfma_f32_32x32x16_bf16 v[32:47], a[108:111], v[108:111], v[32:47]
    ds_read_b128 v[96:99], v238 offset:57344
    ds_read_b128 v[100:103], v242 offset:57344
    buffer_load_dwordx4 v[120:123], v13, s[44:47], s84 offen offset:2048 sc1
    buffer_load_dwordx4 v[124:127], v13, s[44:47], s84 offen offset:3072 sc1
    s_waitcnt vmcnt(8)
    v_mfma_f32_32x32x16_bf16 v[16:31], a[112:115], v[80:83], v[16:31]
    v_mfma_f32_32x32x16_bf16 v[32:47], a[112:115], v[84:87], v[32:47]
    ds_read_b128 v[104:107], v239 offset:57344
    ds_read_b128 v[108:111], v243 offset:57344
    s_xor_b32 s84, s84, 4096
    buffer_load_dwordx4 v[128:131], v13, s[44:47], s84 offen offset:0 sc1
    buffer_load_dwordx4 v[132:135], v13, s[44:47], s84 offen offset:1024 sc1
    s_waitcnt vmcnt(9) lgkmcnt(4)
    v_mfma_f32_32x32x16_bf16 v[16:31], a[116:119], v[88:91], v[16:31]
    v_mfma_f32_32x32x16_bf16 v[32:47], a[116:119], v[92:95], v[32:47]
    buffer_load_dwordx4 v[136:139], v13, s[44:47], s84 offen offset:2048 sc1
    buffer_load_dwordx4 v[140:143], v13, s[44:47], s84 offen offset:3072 sc1
    s_waitcnt vmcnt(10) lgkmcnt(2)
    v_mfma_f32_32x32x16_bf16 v[16:31], a[120:123], v[96:99], v[16:31]
    v_mfma_f32_32x32x16_bf16 v[32:47], a[120:123], v[100:103], v[32:47]
    s_xor_b32 s84, s84, 12288
    buffer_load_dwordx4 v[144:147], v13, s[44:47], s84 offen offset:0 sc1
    buffer_load_dwordx4 v[148:151], v13, s[44:47], s84 offen offset:1024 sc1
    s_waitcnt vmcnt(11) lgkmcnt(0)
    v_mfma_f32_32x32x16_bf16 v[16:31], a[124:127], v[104:107], v[16:31]
    v_mfma_f32_32x32x16_bf16 v[32:47], a[124:127], v[108:111], v[32:47]
    s_branch L_2b
L_slow0:
    s_load_dwordx8 s[8:15], s[44:45], s5 offset:512 glc
    s_waitcnt vmcnt(4)
    v_mfma_f32_32x32x16_bf16 v[16:31], a[108:111], v[104:107], v[16:31]
    v_mfma_f32_32x32x16_bf16 v[32:47], a[108:111], v[108:111], v[32:47]
    ds_read_b128 v[96:99], v238 offset:57344
    ds_read_b128 v[100:103], v242 offset:57344
    s_waitcnt vmcnt(3)
    v_mfma_f32_32x32x16_bf16 v[16:31], a[112:115], v[80:83], v[16:31]
    v_mfma_f32_32x32x16_bf16 v[32:47], a[112:115], v[84:87], v[32:47]
    ds_read_b128 v[104:107], v239 offset:57344
    ds_read_b128 v[108:111], v243 offset:57344
    s_waitcnt vmcnt(2) lgkmcnt(4)
    v_mfma_f32_32x32x16_bf16 v[16:31], a[116:119], v[88:91], v[16:31]
    v_mfma_f32_32x32x16_bf16 v[32:47], a[116:119], v[92:95], v[32:47]
    s_waitcnt vmcnt(1) lgkmcnt(2)
    v_mfma_f32_32x32x16_bf16 v[16:31], a[120:123], v[96:99], v[16:31]
    v_mfma_f32_32x32x16_bf16 v[32:47], a[120:123], v[100:103], v[32:47]
    s_waitcnt vmcnt(0) lgkmcnt(0)
    v_mfma_f32_32x32x16_bf16 v[16:31], a[124:127], v[104:107], v[16:31]
    v_mfma_f32_32x32x16_bf16 v[32:47], a[124:127], v[108:111], v[32:47]
    s_waitcnt lgkmcnt(0)
    s_xor_b32 s8, s8, s66
    s_xor_b32 s9, s9, s66
    s_xor_b32 s10, s10, s66
    s_xor_b32 s11, s11, s66
    s_xor_b32 s12, s12, s66
    s_or_b32 s8, s8, s12
    s_or_b64 s[8:9], s[8:9], s[10:11]
    s_cbranch_scc0 L_po_x
    s_mov_b32 s78, 131072
L_po:
    s_sub_u32 s78, s78, 1
    s_cbranch_scc1 L_po_x
    s_load_dwordx8 s[8:15], s[44:45], s5 offset:512 glc
    s_waitcnt lgkmcnt(0)
    s_xor_b32 s8, s8, s66
    s_xor_b32 s9, s9, s66
    s_xor_b32 s10, s10, s66
    s_xor_b32 s11, s11, s66
    s_xor_b32 s12, s12, s66
    s_or_b32 s8, s8, s12
    s_or_b64 s[8:9], s[8:9], s[10:11]
    s_cbranch_scc1 L_po
L_po_x:
    buffer_load_dword v2, v251, s[44:47], s85 offen sc1
    buffer_load_dwordx4 v[112:115], v13, s[44:47], s84 offen offset:0 sc1
    buffer_load_dwordx4 v[116:119], v13, s[44:47], s84 offen offset:1024 sc1
    buffer_load_dwordx4 v[120:123], v13, s[44:47], s84 offen offset:2048 sc1
    buffer_load_dwordx4 v[124:127], v13, s[44:47], s84 offen offset:3072 sc1
    s_xor_b32 s84, s84, 4096
    buffer_load_dwordx4 v[128:131], v13, s[44:47], s84 offen offset:0 sc1
    buffer_load_dwordx4 v[132:135], v13, s[44:47], s84 offen offset:1024 sc1
    buffer_load_dwordx4 v[136:139], v13, s[44:47], s84 offen offset:2048 sc1
    buffer_load_dwordx4 v[140:143], v13, s[44:47], s84 offen offset:3072 sc1
    s_xor_b32 s84, s84, 12288
    buffer_load_dwordx4 v[144:147], v13, s[44:47], s84 offen offset:0 sc1
    buffer_load_dwordx4 v[148:151], v13, s[44:47], s84 offen offset:1024 sc1
    s_branch L_2b
L_kvretry:
    s_mov_b32 s72, 0
    v_max3_u32 v6, v164, v165, v166
    v_max_u32 v6, v6, v167
    v_cmp_eq_u32 vcc, -1, v6
    s_nop 0
    s_cbranch_vccz L_kvh0
    buffer_load_dword v164, v14, s[44:47], s31 offen offset:0 sc1
    buffer_load_dword v165, v14, s[44:47], s31 offen offset:256 sc1
    buffer_load_dword v166, v14, s[44:47], s31 offen offset:512 sc1
    buffer_load_dword v167, v14, s[44:47], s31 offen offset:768 sc1
    s_mov_b32 s72, 1
L_kvh0:
    v_max3_u32 v6, v16, v17, v18
    v_max_u32 v6, v6, v19
    v_cmp_eq_u32 vcc, -1, v6
    s_nop 0
    s_cbranch_vccz L_kvh1
    s_xor_b32 s3, s30, 0
    buffer_load_dwordx4 v[16:19], v13, s[44:47], s3 offen offset:0 sc1
    s_mov_b32 s72, 1
L_kvh1:
    v_max3_u32 v6, v20, v21, v22
    v_max_u32 v6, v6, v23
    v_cmp_eq_u32 vcc, -1, v6
    s_nop 0
    s_cbranch_vccz L_kvh2
    s_xor_b32 s3, s30, 0
    buffer_load_dwordx4 v[20:23], v13, s[44:47], s3 offen offset:1024 sc1
    s_mov_b32 s72, 1
L_kvh2:
    v_max3_u32 v6, v24, v25, v26
    v_max_u32 v6, v6, v27
    v_cmp_eq_u32 vcc, -1, v6
    s_nop 0
    s_cbranch_vccz L_kvh3
    s_xor_b32 s3, s30, 0
    buffer_load_dwordx4 v[24:27], v13, s[44:47], s3 offen offset:2048 sc1
    s_mov_b32 s72, 1
L_kvh3:
    v_max3_u32 v6, v28, v29, v30
    v_max_u32 v6, v6, v31
    v_cmp_eq_u32 vcc, -1, v6
    s_nop 0
    s_cbranch_vccz L_kvh4
    s_xor_b32 s3, s30, 0
    buffer_load_dwordx4 v[28:31], v13, s[44:47], s3 offen offset:3072 sc1
    s_mov_b32 s72, 1
L_kvh4:
    v_max3_u32 v6, v32, v33, v34
    v_max_u32 v6, v6, v35
    v_cmp_eq_u32 vcc, -1, v6
    s_nop 0
    s_cbranch_vccz L_kvh5
    s_xor_b32 s3, s30, 4096
    buffer_load_dwordx4 v[32:35], v13, s[44:47], s3 offen offset:0 sc1
    s_mov_b32 s72, 1
L_kvh5:
    v_max3_u32 v6, v36, v37, v38
    v_max_u32 v6, v6, v39
    v_cmp_eq_u32 vcc, -1, v6
    s_nop 0
    s_cbranch_vccz L_kvh6
    s_xor_b32 s3, s30, 4096
    buffer_load_dwordx4 v[36:39], v13, s[44:47], s3 offen offset:1024 sc1
    s_mov_b32 s72, 1
L_kvh6:
    v_max3_u32 v6, v40, v41, v42
    v_max_u32 v6, v6, v43
    v_cmp_eq_u32 vcc, -1, v6
    s_nop 0
    s_cbranch_vccz L_kvh7
    s_xor_b32 s3, s30, 4096
    buffer_load_dwordx4 v[40:43], v13, s[44:47], s3 offen offset:2048 sc1
    s_mov_b32 s72, 1
L_kvh7:
    v_max3_u32 v6, v44, v45, v46
    v_max_u32 v6, v6, v47
    v_cmp_eq_u32 vcc, -1, v6
    s_nop 0
    s_cbranch_vccz L_kvh8
    s_xor_b32 s3, s30, 4096
    buffer_load_dwordx4 v[44:47], v13, s[44:47], s3 offen offset:3072 sc1
    s_mov_b32 s72, 1
L_kvh8:
    s_cmp_eq_u32 s72, 0
    s_cbranch_scc1 L_kvok
    s_waitcnt vmcnt(0)
    v_mfma_f32_16x16x32_bf16 v[128:131], v[160:163], v[16:19], 0
    v_add_f32 v4, v164, v165
    v_add_f32 v5, v166, v167
    v_mfma_f32_16x16x32_bf16 v[128:131], v[160:163], v[20:23], v[128:131]
    v_add_f32 v4, v4, v5
    v_mov_b32 v5, v4
    v_mfma_f32_16x16x32_bf16 v[128:131], v[160:163], v[24:27], v[128:131]
    s_nop 0
    v_permlane32_swap_b32 v4, v5
    v_mfma_f32_16x16x32_bf16 v[128:131], v[160:163], v[28:31], v[128:131]
    v_add_f32 v4, v4, v5
    v_mov_b32 v5, v4
    v_mfma_f32_16x16x32_bf16 v[128:131], v[160:163], v[32:35], v[128:131]
    s_nop 0
    v_permlane16_swap_b32 v4, v5
    v_mfma_f32_16x16x32_bf16 v[128:131], v[160:163], v[36:39], v[128:131]
    v_add_f32 v4, v4, v5
    v_cvt_pk_bf16_f32 v134, v4, v4
    v_mfma_f32_16x16x32_bf16 v[128:131], v[160:163], v[40:43], v[128:131]
    v_mfma_f32_16x16x32_bf16 v[128:131], v[160:163], v[44:47], v[128:131]
    s_nop 7
    v_cmp_u_f32 vcc, v4, v128
    s_sub_u32 s78, s78, 1
    s_cbranch_scc1 L_kvok
    s_cbranch_vccnz L_kvretry
    s_branch L_kvok
L_end:
    s_endpgm
.section .rodata,"a"
.p2align 6
.amdhsa_kernel gated_mix__ssm_conv_s5__linear_attn_block__prompt_kernel
  .amdhsa_next_free_vgpr 512
  .amdhsa_next_free_sgpr 102
  .amdhsa_accum_offset 256
  .amdhsa_group_segment_fixed_size 0
  .amdhsa_kernarg_size 128
  .amdhsa_user_sgpr_count 2
  .amdhsa_user_sgpr_kernarg_segment_ptr 1
  .amdhsa_system_sgpr_workgroup_id_x 1
.end_amdhsa_kernel
```
